```python
import torch

def _softmax(x, axis=-1):
    return torch.softmax(x, dim=axis)
def _gelu(x):
    return torch.nn.functional.gelu(x, approximate="tanh")
def _silu(x):
    return torch.nn.functional.silu(x)
def _sigmoid(x):
    return torch.sigmoid(x)
def _layernorm(x, axis=-1, eps=1e-5):
    m = x.mean(dim=axis, keepdim=True)
    v = x.var(dim=axis, keepdim=True, unbiased=False)
    return (x - m) / torch.sqrt(v + eps)
def _scatter_add(tgt, idx, src, axis=0):
    return tgt.clone().index_add_(axis, idx, src)
def _segment_sum(src, seg, n):
    out = torch.zeros((n,) + src.shape[1:], dtype=src.dtype)
    return out.index_add_(0, seg, src)
def _pad(x, pw):
    flat = tuple(v for pair in reversed(pw) for v in pair)
    return torch.nn.functional.pad(x, flat)

kernel_name = 'gather_scatter__mpnn_edge_mlp__graph'

def setup_inputs():

    _w = (lambda a: (lambda t: t.to(torch.bfloat16) if t.is_floating_point() else t)(torch.as_tensor(a)))
    N, deg, D, De = 12500, 32, 128, max(16, 1)
    E = N * deg
    return {
        "x": _w((lambda *s: torch.randn(*s, dtype=torch.bfloat16) * 0.05)(N, D)),
        "e_attr": _w((lambda *s: torch.randn(*s, dtype=torch.bfloat16) * 0.4)(E, De)),
        "src": _w((lambda lo, hi, *s: torch.randint(lo, hi, s))(0, N, E).to(torch.int64)),
        "dst": _w((lambda lo, hi, *s: torch.randint(lo, hi, s))(0, N, E).to(torch.int64)),
        "w_msg": _w((lambda *s: torch.randn(*s, dtype=torch.bfloat16) * 0.4)(2 * D + De, D)),
        "w_upd": _w((lambda *s: torch.randn(*s, dtype=torch.bfloat16) * 0.05)(2 * D, D)),
    }

def reference(x, e_attr, src, dst, w_msg, w_upd):
    N, D = x.shape
    m_in = torch.concatenate([x[src], x[dst], e_attr], axis=-1)
    msg = _silu(m_in @ w_msg)
    agg = _segment_sum(msg, dst, N)
    return _silu(torch.concatenate([x, agg], axis=-1) @ w_upd)
```

```asm
; @launch kernel=prep_kernel grid=(256,1,1) block=(512,1,1) lds=91648
; @launch kernel=gather_scatter__mpnn_edge_mlp__graph_kernel grid=(256,1,1) block=(512,1,1) lds=163840
.amdgcn_target "amdgcn-amd-amdhsa--gfx950"
.text
.globl prep_kernel
.p2align 8
.type prep_kernel,@function
prep_kernel:
    s_load_dwordx16 s[4:19], s[0:1], 0
    s_load_dwordx2 s[20:21], s[0:1], 64
    v_and_b32 v1, 63, v0
    v_lshrrev_b32 v2, 6, v0
    s_nop 0
    v_readfirstlane_b32 s22, v2
    s_mov_b32 s23, s2
    s_cmp_lt_u32 s2, 120
    s_cbranch_scc1 K1_BIN
    s_sub_u32 s23, s2, 3
    s_sub_u32 s3, s2, 123
    s_cmp_lt_u32 s3, 5
    s_cbranch_scc1 K1_BIN
    s_cmp_ge_u32 s2, 256
    s_cbranch_scc1 K1_END
    s_and_b32 s44, s2, 7
    s_lshr_b32 s23, s2, 3
    s_lshl4_add_u32 s23, s44, s23
    s_min_u32 s44, s44, 2
    s_add_u32 s23, s23, s44
    s_sub_u32 s23, s23, 15
    s_mul_i32 s46, s23, 24576
    s_sub_u32 s48, 3200000, s46
    s_min_u32 s48, s48, 24576
    v_lshrrev_b32 v2, 4, v1
    v_and_b32 v3, 15, v1
    v_xor_b32 v3, v3, v2
    v_lshlrev_b32 v3, 4, v3
    v_lshl_add_u32 v16, v2, 8, v3
    v_xor_b32 v17, 64, v16
    v_xor_b32 v18, 128, v16
    v_xor_b32 v19, 192, v16
    v_lshrrev_b32 v5, 4, v1
    v_and_b32 v4, 15, v1
    v_lshlrev_b32 v4, 4, v4
    v_lshlrev_b32 v6, 6, v5
    v_xor_b32 v4, v4, v6
    v_lshl_add_u32 v4, v5, 8, v4
    s_lshl_b32 s47, s22, 12
    s_waitcnt lgkmcnt(0)
    s_mov_b32 m0, s47
    s_add_u32 s24, s4, s46
    s_addc_u32 s25, s5, 0
    s_mov_b32 s26, s48
    s_mov_b32 s27, 0x20000
    buffer_load_dwordx4 v16, s[24:27], s47 offen  lds
    buffer_load_dwordx4 v17, s[24:27], s47 offen offset:1024  lds
    buffer_load_dwordx4 v18, s[24:27], s47 offen offset:2048  lds
    buffer_load_dwordx4 v19, s[24:27], s47 offen offset:3072  lds
    s_mov_b32 s28, s12
    s_mov_b32 s29, s13
    s_mov_b32 s30, 32768
    s_mov_b32 s31, 0x20000
    s_add_u32 s44, s47, 0
    s_add_u32 m0, s47, 32768
    s_nop 0
    buffer_load_dwordx4 v4, s[28:31], s44 offen lds
    buffer_load_dwordx4 v4, s[28:31], s44 offen offset:1024 lds
    buffer_load_dwordx4 v4, s[28:31], s44 offen offset:2048 lds
    buffer_load_dwordx4 v4, s[28:31], s44 offen offset:3072 lds
    s_add_u32 s32, s20, s46
    s_addc_u32 s33, s21, 0
    s_add_u32 s32, s32, 4096
    s_addc_u32 s33, s33, 0
    s_mov_b32 s34, s48
    s_mov_b32 s35, 0x20000
    v_lshrrev_b32 v9, 5, v1
    v_bfe_u32 v10, v1, 2, 2
    v_lshl_add_u32 v9, v9, 3, v10
    v_lshlrev_b32 v8, 8, v9
    v_and_b32 v9, 1, v1
    v_lshlrev_b32 v9, 5, v9
    v_bfe_u32 v11, v1, 1, 1
    v_lshl_add_u32 v9, v11, 3, v9
    v_bfe_u32 v11, v1, 4, 1
    v_lshl_add_u32 v9, v11, 4, v9
    s_and_b32 s44, s22, 3
    s_lshl_b32 s44, s44, 6
    v_add_u32 v9, s44, v9
    v_lshlrev_b32 v10, 6, v10
    v_xor_b32 v9, v9, v10
    v_add_u32 v8, v8, v9
    v_and_b32 v12, 31, v1
    v_lshrrev_b32 v13, 5, v1
    v_and_b32 v15, 15, v1
    v_xor_b32 v15, v15, v13
    v_lshlrev_b32 v15, 4, v15
    v_lshl_add_u32 v15, v12, 8, v15
    s_lshr_b32 s44, s22, 2
    s_lshl_b32 s45, s44, 14
    v_add_u32 v20, s45, v15
    v_xor_b32 v21, 32, v20
    v_xor_b32 v22, 64, v20
    v_xor_b32 v23, 96, v20
    v_xor_b32 v24, 128, v20
    v_xor_b32 v25, 160, v20
    v_xor_b32 v26, 192, v20
    v_xor_b32 v27, 224, v20
    v_lshlrev_b32 v13, 5, v13
    v_mul_u32_u24 v12, 272, v12
    s_mul_i32 s44, s44, 17408
    s_and_b32 s45, s22, 3
    s_lshl_b32 s45, s45, 6
    s_add_u32 s44, s44, s45
    s_add_u32 s44, s44, 65536
    v_add3_u32 v12, s44, v12, v13
    v_lshrrev_b32 v13, 4, v0
    v_lshlrev_b32 v14, 4, v0
    v_lshl_add_u32 v13, v13, 4, v14
    v_add_u32 v13, 65536, v13
    s_mov_b32 s44, 0xbfb8aa3b
    s_mov_b32 s45, 0xbfb8aa3b
    s_movk_i32 s62, 8192
    s_movk_i32 s63, 16384
    s_movk_i32 s64, 24576
    s_cmp_ge_u32 s22, 4
    s_waitcnt vmcnt(4)
    s_barrier
    ds_read_b128 v[64:67], v20
    ds_read_b128 v[68:71], v21
    ds_read_b128 v[72:75], v22
    ds_read_b128 v[76:79], v23
    ds_read_b128 v[80:83], v24
    ds_read_b128 v[84:87], v25
    ds_read_b128 v[88:91], v26
    ds_read_b128 v[92:95], v27
    s_cbranch_scc1 K1_NX1
    ds_read_b128 v[96:99], v20 offset:8192
    ds_read_b128 v[100:103], v21 offset:8192
    ds_read_b128 v[104:107], v22 offset:8192
    ds_read_b128 v[108:111], v23 offset:8192
    ds_read_b128 v[112:115], v24 offset:8192
    ds_read_b128 v[116:119], v25 offset:8192
    ds_read_b128 v[120:123], v26 offset:8192
    ds_read_b128 v[124:127], v27 offset:8192
K1_NX1:
    s_waitcnt vmcnt(0)
    s_barrier
    ds_read_b64_tr_b16 v[32:33], v8 offset:32768
    ds_read_b64_tr_b16 v[34:35], v8 offset:33792
    ds_read_b64_tr_b16 v[36:37], v8 offset:36864
    ds_read_b64_tr_b16 v[38:39], v8 offset:37888
    ds_read_b64_tr_b16 v[40:41], v8 offset:40960
    ds_read_b64_tr_b16 v[42:43], v8 offset:41984
    ds_read_b64_tr_b16 v[44:45], v8 offset:45056
    ds_read_b64_tr_b16 v[46:47], v8 offset:46080
    ds_read_b64_tr_b16 v[48:49], v8 offset:49152
    ds_read_b64_tr_b16 v[50:51], v8 offset:50176
    ds_read_b64_tr_b16 v[52:53], v8 offset:53248
    ds_read_b64_tr_b16 v[54:55], v8 offset:54272
    ds_read_b64_tr_b16 v[56:57], v8 offset:57344
    ds_read_b64_tr_b16 v[58:59], v8 offset:58368
    ds_read_b64_tr_b16 v[60:61], v8 offset:61440
    ds_read_b64_tr_b16 v[62:63], v8 offset:62464
    s_waitcnt lgkmcnt(14)
    v_mfma_f32_32x32x16_bf16 v[128:143], v[32:35], v[64:67], 0
    s_waitcnt lgkmcnt(12)
    v_mfma_f32_32x32x16_bf16 v[128:143], v[36:39], v[68:71], v[128:143]
    s_waitcnt lgkmcnt(10)
    v_mfma_f32_32x32x16_bf16 v[128:143], v[40:43], v[72:75], v[128:143]
    s_waitcnt lgkmcnt(8)
    v_mfma_f32_32x32x16_bf16 v[128:143], v[44:47], v[76:79], v[128:143]
    s_waitcnt lgkmcnt(6)
    v_mfma_f32_32x32x16_bf16 v[128:143], v[48:51], v[80:83], v[128:143]
    s_waitcnt lgkmcnt(4)
    v_mfma_f32_32x32x16_bf16 v[128:143], v[52:55], v[84:87], v[128:143]
    s_waitcnt lgkmcnt(2)
    v_mfma_f32_32x32x16_bf16 v[128:143], v[56:59], v[88:91], v[128:143]
    s_waitcnt lgkmcnt(0)
    v_mfma_f32_32x32x16_bf16 v[128:143], v[60:63], v[92:95], v[128:143]
    s_cbranch_scc1 K1_NX2
    v_mfma_f32_32x32x16_bf16 v[144:159], v[32:35], v[96:99], 0
    v_mfma_f32_32x32x16_bf16 v[144:159], v[36:39], v[100:103], v[144:159]
    v_mfma_f32_32x32x16_bf16 v[144:159], v[40:43], v[104:107], v[144:159]
    v_mfma_f32_32x32x16_bf16 v[144:159], v[44:47], v[108:111], v[144:159]
    v_mfma_f32_32x32x16_bf16 v[144:159], v[48:51], v[112:115], v[144:159]
    v_mfma_f32_32x32x16_bf16 v[144:159], v[52:55], v[116:119], v[144:159]
    v_mfma_f32_32x32x16_bf16 v[144:159], v[56:59], v[120:123], v[144:159]
    v_mfma_f32_32x32x16_bf16 v[144:159], v[60:63], v[124:127], v[144:159]
    s_nop 2
    v_pk_mul_f32 v[128:129], v[128:129], s[44:45]
    v_pk_mul_f32 v[130:131], v[130:131], s[44:45]
    v_pk_mul_f32 v[132:133], v[132:133], s[44:45]
    v_pk_mul_f32 v[134:135], v[134:135], s[44:45]
    v_pk_mul_f32 v[136:137], v[136:137], s[44:45]
    v_pk_mul_f32 v[138:139], v[138:139], s[44:45]
    v_pk_mul_f32 v[140:141], v[140:141], s[44:45]
    v_pk_mul_f32 v[142:143], v[142:143], s[44:45]
    v_cvt_pk_bf16_f32 v128, v128, v129
    v_cvt_pk_bf16_f32 v129, v130, v131
    v_cvt_pk_bf16_f32 v130, v132, v133
    v_cvt_pk_bf16_f32 v131, v134, v135
    v_cvt_pk_bf16_f32 v132, v136, v137
    v_cvt_pk_bf16_f32 v133, v138, v139
    v_cvt_pk_bf16_f32 v134, v140, v141
    v_cvt_pk_bf16_f32 v135, v142, v143
    ds_write_b128 v12, v[128:131] offset:0
    ds_write_b128 v12, v[132:135] offset:16
    v_pk_mul_f32 v[144:145], v[144:145], s[44:45]
    v_pk_mul_f32 v[146:147], v[146:147], s[44:45]
    v_pk_mul_f32 v[148:149], v[148:149], s[44:45]
    v_pk_mul_f32 v[150:151], v[150:151], s[44:45]
    v_pk_mul_f32 v[152:153], v[152:153], s[44:45]
    v_pk_mul_f32 v[154:155], v[154:155], s[44:45]
    v_pk_mul_f32 v[156:157], v[156:157], s[44:45]
    v_pk_mul_f32 v[158:159], v[158:159], s[44:45]
    v_cvt_pk_bf16_f32 v144, v144, v145
    v_cvt_pk_bf16_f32 v145, v146, v147
    v_cvt_pk_bf16_f32 v146, v148, v149
    v_cvt_pk_bf16_f32 v147, v150, v151
    v_cvt_pk_bf16_f32 v148, v152, v153
    v_cvt_pk_bf16_f32 v149, v154, v155
    v_cvt_pk_bf16_f32 v150, v156, v157
    v_cvt_pk_bf16_f32 v151, v158, v159
    ds_write_b128 v12, v[144:147] offset:8704
    ds_write_b128 v12, v[148:151] offset:8720
    s_branch K1_NX3
K1_NX2:
    s_nop 10
    v_pk_mul_f32 v[128:129], v[128:129], s[44:45]
    v_pk_mul_f32 v[130:131], v[130:131], s[44:45]
    v_pk_mul_f32 v[132:133], v[132:133], s[44:45]
    v_pk_mul_f32 v[134:135], v[134:135], s[44:45]
    v_pk_mul_f32 v[136:137], v[136:137], s[44:45]
    v_pk_mul_f32 v[138:139], v[138:139], s[44:45]
    v_pk_mul_f32 v[140:141], v[140:141], s[44:45]
    v_pk_mul_f32 v[142:143], v[142:143], s[44:45]
    v_cvt_pk_bf16_f32 v128, v128, v129
    v_cvt_pk_bf16_f32 v129, v130, v131
    v_cvt_pk_bf16_f32 v130, v132, v133
    v_cvt_pk_bf16_f32 v131, v134, v135
    v_cvt_pk_bf16_f32 v132, v136, v137
    v_cvt_pk_bf16_f32 v133, v138, v139
    v_cvt_pk_bf16_f32 v134, v140, v141
    v_cvt_pk_bf16_f32 v135, v142, v143
    ds_write_b128 v12, v[128:131] offset:0
    ds_write_b128 v12, v[132:135] offset:16
K1_NX3:
    s_waitcnt lgkmcnt(0)
    s_barrier
    ds_read_b128 v[48:51], v13 offset:0
    ds_read_b128 v[52:55], v13 offset:8704
    ds_read_b128 v[56:59], v13 offset:17408
    s_waitcnt lgkmcnt(2)
    buffer_store_dwordx4 v[48:51], v14, s[32:35], 0 offen sc1
    s_waitcnt lgkmcnt(1)
    buffer_store_dwordx4 v[52:55], v14, s[32:35], s62 offen sc1
    s_waitcnt lgkmcnt(0)
    buffer_store_dwordx4 v[56:59], v14, s[32:35], s63 offen sc1
    s_endpgm
K1_BIN:
    s_mul_i32 s46, s23, 12800
    s_lshl_b32 s47, s23, 15
    v_lshlrev_b32 v2, 4, v0
    s_movk_i32 s3, 6400
    s_movk_i32 s59, 400
    v_cmp_gt_u32 s[60:61], s59, v0
    s_waitcnt lgkmcnt(0)
    s_add_u32 s24, s10, s46
    s_addc_u32 s25, s11, 0
    s_mov_b32 s26, 12800
    s_mov_b32 s27, 0x20000
    buffer_load_dwordx4 v[4:7], v2, s[24:27], 0 offen nt
    buffer_load_dwordx4 v[8:11], v2, s[24:27], s3 offen nt
    s_add_u32 s28, s8, s46
    s_addc_u32 s29, s9, 0
    s_mov_b32 s30, 12800
    s_mov_b32 s31, 0x20000
    buffer_load_dwordx4 v[12:15], v2, s[28:31], 0 offen nt
    buffer_load_dwordx4 v[16:19], v2, s[28:31], s3 offen nt
    s_add_u32 s32, s20, s47
    s_addc_u32 s33, s21, 0
    s_add_u32 s32, s32, 3276800
    s_addc_u32 s33, s33, 0
    s_mov_b32 s34, 32768
    s_mov_b32 s35, 0x20000
    v_mov_b32 v44, 1
    v_min_u32 v3, 256, v0
    v_mul_u32_u24 v3, 144, v3
    ds_write_b32 v3, v44 offset:0
    v_lshlrev_b32 v45, 22, v0
    s_movk_i32 s58, 10700
    s_movk_i32 s57, 144
    v_lshrrev_b32 v46, 3, v0
    v_lshl_add_u32 v46, v46, 4, v2
    v_mov_b32 v48, 36864
    s_movk_i32 s62, 8192
    s_movk_i32 s63, 16384
    s_movk_i32 s64, 24576
    s_waitcnt lgkmcnt(0)
    s_barrier
    s_cmp_lg_u32 s22, 7
    s_cbranch_scc1 K1_NOTOUCH
    s_cmp_ge_u32 s2, 124
    s_cbranch_scc1 K1_W3
    s_lshr_b32 s44, s2, 3
    v_lshlrev_b32 v70, 7, v1
    s_add_u32 s72, s12, 32768
    s_addc_u32 s73, s13, 0
    s_mov_b32 s74, 32768
    s_mov_b32 s75, 0x20000
    s_mov_b32 s76, s14
    s_mov_b32 s77, s15
    s_mov_b32 s78, 65536
    s_mov_b32 s79, 0x20000
    s_mul_i32 s45, s44, 2304
    s_mov_b64 exec, 0x3ffff
    buffer_load_dword v71, v70, s[72:75], s45 offen
    s_mul_i32 s45, s44, 4480
    s_mov_b32 exec_lo, -1
    s_mov_b32 exec_hi, 7
    buffer_load_dword v72, v70, s[76:79], s45 offen
    s_mov_b64 exec, -1
    s_branch K1_B2
K1_NOTOUCH:
    s_mov_b64 exec, s[60:61]
    s_waitcnt vmcnt(3)
    v_mul_u32_u24 v36, s58, v4
    v_lshrrev_b32 v36, 19, v36
    v_mul_u32_u24 v20, s57, v36
    ds_add_rtn_u32 v28, v20, v44 offset:0
    v_mul_u32_u24 v37, s58, v5
    v_lshrrev_b32 v37, 19, v37
    v_mul_u32_u24 v21, s57, v37
    ds_add_rtn_u32 v29, v21, v44 offset:0
    v_mul_u32_u24 v38, s58, v6
    v_lshrrev_b32 v38, 19, v38
    v_mul_u32_u24 v22, s57, v38
    ds_add_rtn_u32 v30, v22, v44 offset:0
    v_mul_u32_u24 v39, s58, v7
    v_lshrrev_b32 v39, 19, v39
    v_mul_u32_u24 v23, s57, v39
    ds_add_rtn_u32 v31, v23, v44 offset:0
    s_waitcnt vmcnt(2)
    v_mul_u32_u24 v40, s58, v8
    v_lshrrev_b32 v40, 19, v40
    v_mul_u32_u24 v24, s57, v40
    ds_add_rtn_u32 v32, v24, v44 offset:0
    v_mul_u32_u24 v41, s58, v9
    v_lshrrev_b32 v41, 19, v41
    v_mul_u32_u24 v25, s57, v41
    ds_add_rtn_u32 v33, v25, v44 offset:0
    v_mul_u32_u24 v42, s58, v10
    v_lshrrev_b32 v42, 19, v42
    v_mul_u32_u24 v26, s57, v42
    ds_add_rtn_u32 v34, v26, v44 offset:0
    v_mul_u32_u24 v43, s58, v11
    v_lshrrev_b32 v43, 19, v43
    v_mul_u32_u24 v27, s57, v43
    ds_add_rtn_u32 v35, v27, v44 offset:0
    v_mul_u32_u24 v36, 49, v36
    v_sub_u32 v4, v4, v36
    v_or_b32 v4, v4, v45
    v_mul_u32_u24 v37, 49, v37
    v_sub_u32 v5, v5, v37
    v_add_u32 v45, 0x100000, v45
    v_or_b32 v5, v5, v45
    v_mul_u32_u24 v38, 49, v38
    v_sub_u32 v6, v6, v38
    v_add_u32 v45, 0x100000, v45
    v_or_b32 v6, v6, v45
    v_mul_u32_u24 v39, 49, v39
    v_sub_u32 v7, v7, v39
    v_add_u32 v45, 0x100000, v45
    v_or_b32 v7, v7, v45
    v_mul_u32_u24 v40, 49, v40
    v_sub_u32 v8, v8, v40
    v_add_u32 v45, 0x63d00000, v45
    v_or_b32 v8, v8, v45
    v_mul_u32_u24 v41, 49, v41
    v_sub_u32 v9, v9, v41
    v_add_u32 v45, 0x100000, v45
    v_or_b32 v9, v9, v45
    v_mul_u32_u24 v42, 49, v42
    v_sub_u32 v10, v10, v42
    v_add_u32 v45, 0x100000, v45
    v_or_b32 v10, v10, v45
    v_mul_u32_u24 v43, 49, v43
    v_sub_u32 v11, v11, v43
    v_add_u32 v45, 0x100000, v45
    v_or_b32 v11, v11, v45
    s_waitcnt vmcnt(0)
    s_waitcnt lgkmcnt(7)
    v_min_u32 v36, 32, v28
    v_lshl_or_b32 v4, v12, 6, v4
    v_lshl_add_u32 v36, v36, 2, v20
    ds_write_b32 v36, v4 offset:0
    s_waitcnt lgkmcnt(7)
    v_min_u32 v37, 32, v29
    v_lshl_or_b32 v5, v13, 6, v5
    v_lshl_add_u32 v37, v37, 2, v21
    ds_write_b32 v37, v5 offset:0
    s_waitcnt lgkmcnt(7)
    v_min_u32 v38, 32, v30
    v_lshl_or_b32 v6, v14, 6, v6
    v_lshl_add_u32 v38, v38, 2, v22
    ds_write_b32 v38, v6 offset:0
    s_waitcnt lgkmcnt(7)
    v_min_u32 v39, 32, v31
    v_lshl_or_b32 v7, v15, 6, v7
    v_lshl_add_u32 v39, v39, 2, v23
    ds_write_b32 v39, v7 offset:0
    s_waitcnt lgkmcnt(7)
    v_min_u32 v40, 32, v32
    v_lshl_or_b32 v8, v16, 6, v8
    v_lshl_add_u32 v40, v40, 2, v24
    ds_write_b32 v40, v8 offset:0
    s_waitcnt lgkmcnt(7)
    v_min_u32 v41, 32, v33
    v_lshl_or_b32 v9, v17, 6, v9
    v_lshl_add_u32 v41, v41, 2, v25
    ds_write_b32 v41, v9 offset:0
    s_waitcnt lgkmcnt(7)
    v_min_u32 v42, 32, v34
    v_lshl_or_b32 v10, v18, 6, v10
    v_lshl_add_u32 v42, v42, 2, v26
    ds_write_b32 v42, v10 offset:0
    s_waitcnt lgkmcnt(7)
    v_min_u32 v43, 32, v35
    v_lshl_or_b32 v11, v19, 6, v11
    v_lshl_add_u32 v43, v43, 2, v27
    ds_write_b32 v43, v11 offset:0
    v_max3_u32 v47, v28, v29, v30
    v_max3_u32 v47, v47, v31, v32
    v_max3_u32 v47, v47, v33, v34
    v_max_u32 v47, v47, v35
    v_cmpx_le_u32 vcc, 32, v47
    ds_write_b32 v48, v47
    s_mov_b64 exec, -1
    s_waitcnt lgkmcnt(0)
K1_B2:
    s_barrier
    ds_read_b128 v[52:55], v46 offset:0
    ds_read_b128 v[56:59], v46 offset:9216
    ds_read_b128 v[60:63], v46 offset:18432
    ds_read_b128 v[64:67], v46 offset:27648
    ds_read_b32 v49, v48
    s_waitcnt lgkmcnt(4)
    buffer_store_dwordx4 v[52:55], v2, s[32:35], 0 offen sc1
    s_waitcnt lgkmcnt(3)
    buffer_store_dwordx4 v[56:59], v2, s[32:35], s62 offen sc1
    s_waitcnt lgkmcnt(2)
    buffer_store_dwordx4 v[60:63], v2, s[32:35], s63 offen sc1
    s_waitcnt lgkmcnt(1)
    buffer_store_dwordx4 v[64:67], v2, s[32:35], s64 offen sc1
    s_waitcnt lgkmcnt(0)
    v_readfirstlane_b32 s3, v49
    s_cmp_lg_u32 s3, 1
    s_cbranch_scc1 K1_FULL
K1_END:
    s_endpgm
K1_FULL:
    s_waitcnt vmcnt(0)
    s_lshl_b32 s48, s23, 2
    s_add_u32 s32, s20, s46
    s_addc_u32 s33, s21, 0
    s_add_u32 s32, s32, 9437184
    s_addc_u32 s33, s33, 0
    s_mov_b32 s34, 12800
    s_mov_b32 s35, 0x20000
    s_add_u32 s36, s20, s48
    s_addc_u32 s37, s21, 0
    s_add_u32 s36, s36, 11075584
    s_addc_u32 s37, s37, 0
    s_mov_b32 s38, 261124
    s_mov_b32 s39, 0x20000
    v_mul_u32_u24 v3, 576, v1
    ds_read_b32 v52, v3 offset:0
    ds_read_b32 v53, v3 offset:144
    ds_read_b32 v54, v3 offset:288
    ds_read_b32 v55, v3 offset:432
    s_waitcnt lgkmcnt(0)
    v_add_u32 v52, -1, v52
    v_add_u32 v53, -1, v53
    v_add_u32 v54, -1, v54
    v_add_u32 v55, -1, v55
    v_add_u32 v56, v52, v53
    v_add_u32 v57, v56, v54
    v_add_u32 v58, v57, v55
    v_mov_b32 v60, v58
    s_nop 1
    v_add_u32_dpp v60, v60, v60 row_shr:1 row_mask:0xf bank_mask:0xf bound_ctrl:0
    s_nop 1
    v_add_u32_dpp v60, v60, v60 row_shr:2 row_mask:0xf bank_mask:0xf bound_ctrl:0
    s_nop 1
    v_add_u32_dpp v60, v60, v60 row_shr:4 row_mask:0xf bank_mask:0xf bound_ctrl:0
    s_nop 1
    v_add_u32_dpp v60, v60, v60 row_shr:8 row_mask:0xf bank_mask:0xf bound_ctrl:0
    s_nop 1
    v_add_u32_dpp v60, v60, v60 row_bcast:15 row_mask:0xa bank_mask:0xf
    s_nop 1
    v_add_u32_dpp v60, v60, v60 row_bcast:31 row_mask:0xc bank_mask:0xf
    v_sub_u32 v60, v60, v58
    v_add_u32 v61, v60, v52
    v_add_u32 v62, v60, v56
    v_add_u32 v63, v60, v57
    ds_write_b32 v3, v60 offset:132
    ds_write_b32 v3, v61 offset:276
    ds_write_b32 v3, v62 offset:420
    ds_write_b32 v3, v63 offset:564
    s_cmp_lg_u32 s22, 7
    s_cbranch_scc1 K1_NOFFT
    v_lshlrev_b32 v59, 12, v1
    buffer_store_dword v60, v59, s[36:39], 0 offen
    buffer_store_dword v61, v59, s[36:39], 0 offen offset:1024
    buffer_store_dword v62, v59, s[36:39], 0 offen offset:2048
    buffer_store_dword v63, v59, s[36:39], 0 offen offset:3072
K1_NOFFT:
    s_mov_b64 exec, s[60:61]
    s_waitcnt lgkmcnt(0)
    ds_read_b32 v20, v20 offset:132
    ds_read_b32 v21, v21 offset:132
    ds_read_b32 v22, v22 offset:132
    ds_read_b32 v23, v23 offset:132
    ds_read_b32 v24, v24 offset:132
    ds_read_b32 v25, v25 offset:132
    ds_read_b32 v26, v26 offset:132
    ds_read_b32 v27, v27 offset:132
    s_waitcnt lgkmcnt(0)
    v_add_lshl_u32 v20, v20, v28, 2
    ds_write_b32 v20, v4 offset:36876
    v_add_lshl_u32 v21, v21, v29, 2
    ds_write_b32 v21, v5 offset:36876
    v_add_lshl_u32 v22, v22, v30, 2
    ds_write_b32 v22, v6 offset:36876
    v_add_lshl_u32 v23, v23, v31, 2
    ds_write_b32 v23, v7 offset:36876
    v_add_lshl_u32 v24, v24, v32, 2
    ds_write_b32 v24, v8 offset:36876
    v_add_lshl_u32 v25, v25, v33, 2
    ds_write_b32 v25, v9 offset:36876
    v_add_lshl_u32 v26, v26, v34, 2
    ds_write_b32 v26, v10 offset:36876
    v_add_lshl_u32 v27, v27, v35, 2
    ds_write_b32 v27, v11 offset:36876
    s_mov_b64 exec, -1
    s_waitcnt lgkmcnt(0)
    s_barrier
    ds_read_b128 v[4:7], v2 offset:36880
    ds_read_b128 v[8:11], v2 offset:45072
    s_waitcnt lgkmcnt(0)
    buffer_store_dwordx4 v[4:7], v2, s[32:35], 0 offen
    buffer_store_dwordx4 v[8:11], v2, s[32:35], s62 offen
    s_endpgm
K1_W3:
    s_sub_u32 s44, s2, 124
    s_add_u32 s72, s12, 65536
    s_addc_u32 s73, s13, 0
    s_mov_b32 s74, 4096
    s_mov_b32 s75, 0x20000
    s_add_u32 s76, s20, 11337728
    s_addc_u32 s77, s21, 0
    s_mov_b32 s78, 4096
    s_mov_b32 s79, 0x20000
    v_and_b32 v70, 31, v1
    v_lshlrev_b32 v70, 1, v70
    v_lshrrev_b32 v71, 5, v1
    v_lshl_add_u32 v70, v71, 11, v70
    s_lshl_b32 s45, s44, 6
    buffer_load_ushort v72, v70, s[72:75], s45 offen
    buffer_load_ushort v73, v70, s[72:75], s45 offen offset:256
    buffer_load_ushort v74, v70, s[72:75], s45 offen offset:512
    buffer_load_ushort v75, v70, s[72:75], s45 offen offset:768
    buffer_load_ushort v76, v70, s[72:75], s45 offen offset:1024
    buffer_load_ushort v77, v70, s[72:75], s45 offen offset:1280
    buffer_load_ushort v78, v70, s[72:75], s45 offen offset:1536
    buffer_load_ushort v79, v70, s[72:75], s45 offen offset:1792
    s_lshl_b32 s45, s44, 10
    s_mov_b32 s44, 0xbfb8aa3b
    v_lshlrev_b32 v71, 4, v1
    s_waitcnt vmcnt(0)
    v_lshlrev_b32 v72, 16, v72
    v_mul_f32 v72, s44, v72
    v_lshlrev_b32 v73, 16, v73
    v_mul_f32 v73, s44, v73
    v_lshlrev_b32 v74, 16, v74
    v_mul_f32 v74, s44, v74
    v_lshlrev_b32 v75, 16, v75
    v_mul_f32 v75, s44, v75
    v_lshlrev_b32 v76, 16, v76
    v_mul_f32 v76, s44, v76
    v_lshlrev_b32 v77, 16, v77
    v_mul_f32 v77, s44, v77
    v_lshlrev_b32 v78, 16, v78
    v_mul_f32 v78, s44, v78
    v_lshlrev_b32 v79, 16, v79
    v_mul_f32 v79, s44, v79
    v_cvt_pk_bf16_f32 v80, v72, v73
    v_cvt_pk_bf16_f32 v81, v74, v75
    v_cvt_pk_bf16_f32 v82, v76, v77
    v_cvt_pk_bf16_f32 v83, v78, v79
    buffer_store_dwordx4 v[80:83], v71, s[76:79], s45 offen sc1
    s_branch K1_B2
.text
.globl gather_scatter__mpnn_edge_mlp__graph_kernel
.p2align 8
.type gather_scatter__mpnn_edge_mlp__graph_kernel,@function
gather_scatter__mpnn_edge_mlp__graph_kernel:
    s_load_dwordx16 s[4:19], s[0:1], 0
    s_load_dwordx2 s[20:21], s[0:1], 64
    v_lshrrev_b32 v41, 2, v0
    v_and_b32 v63, 3, v0
    s_cmp_ge_u32 s2, 256
    s_cbranch_scc1 K2_END
    s_and_b32 s70, s2, 7
    s_lshr_b32 s23, s2, 3
    s_lshl_b32 s70, s70, 5
    s_add_u32 s23, s23, s70
    v_mul_u32_u24 v6, 3200, v41
    v_lshlrev_b32 v44, 4, v63
    s_lshl_b32 s72, s23, 7
    s_add_u32 s72, s72, 3276800
    v_lshl_add_u32 v42, v41, 15, v44
    s_mov_b32 s54, 4063360
    s_mov_b32 s55, 0x20000
    v_lshrrev_b32 v40, 6, v0
    v_and_b32 v1, 63, v0
    v_readfirstlane_b32 s22, v40
    s_mul_i32 s73, s23, 12544
    s_sub_u32 s74, 3200000, s73
    s_min_u32 s74, s74, 12544
    v_mov_b32 v48, 0
    v_mov_b32 v49, 0
    v_mov_b32 v50, 0
    v_mov_b32 v51, 0
    v_lshlrev_b32 v62, 4, v1
    s_mov_b64 exec, 0x1ffff
    ds_write_b128 v62, v[48:51] offset:0
    s_mov_b64 exec, -1
    v_lshrrev_b32 v58, 4, v1
    v_and_b32 v59, 15, v1
    v_xor_b32 v59, v59, v58
    v_lshlrev_b32 v59, 4, v59
    v_lshl_add_u32 v58, v58, 8, v59
    s_and_b32 s86, s22, 1
    s_lshl_b32 s86, s86, 7
    v_xor_b32 v58, s86, v58
    v_xor_b32 v59, 64, v58
    s_lshr_b32 s87, s22, 1
    s_lshl_b32 s87, s87, 12
    s_lshl_b32 s86, s22, 11
    s_add_u32 s87, s87, s86
    s_add_u32 s87, s87, 98304
    v_lshrrev_b32 v52, 4, v1
    v_and_b32 v35, 15, v1
    v_lshlrev_b32 v35, 4, v35
    v_lshlrev_b32 v53, 6, v52
    v_xor_b32 v35, v35, v53
    v_lshl_add_u32 v35, v52, 8, v35
    s_lshl_b32 s64, s22, 12
    s_lshl_b32 s65, s22, 13
    s_add_u32 s84, s65, 102400
    s_add_u32 s65, s65, 98048
    s_add_u32 s85, s64, 32768
    v_lshlrev_b32 v47, 4, v0
    s_and_b32 s71, s22, 4
    s_add_u32 s70, s22, s71
    s_lshl_b32 s70, s70, 10
    s_add_u32 m0, s70, 131072
    s_mov_b32 s42, 4096
    s_mov_b32 s43, 0x20000
    s_waitcnt lgkmcnt(0)
    s_add_u32 s52, s20, s72
    s_addc_u32 s53, s21, 0
    buffer_load_dwordx4 v[160:163], v42, s[52:55], 0 offen
    buffer_load_dwordx4 v[164:167], v42, s[52:55], 0 offen offset:64
    s_add_u32 s40, s20, 11337728
    s_addc_u32 s41, s21, 0
    buffer_load_dwordx4 v47, s[40:43], 0 offen lds
    s_add_u32 s32, s4, s73
    s_addc_u32 s33, s5, 0
    s_mov_b32 s34, s74
    s_mov_b32 s35, 0x20000
    s_add_u32 s36, s16, s73
    s_addc_u32 s37, s17, 0
    s_mov_b32 s38, s74
    s_mov_b32 s39, 0x20000
    s_add_u32 s44, s12, 32768
    s_addc_u32 s45, s13, 0
    s_mov_b32 s46, 32768
    s_mov_b32 s47, 0x20000
    s_mov_b32 s48, s14
    s_mov_b32 s49, s15
    s_mov_b32 s50, 65536
    s_mov_b32 s51, 0x20000
    s_barrier
    s_mov_b32 m0, s87
    s_nop 0
    buffer_load_dwordx4 v58, s[32:35], s86 offen  lds
    v_and_b32 v53, 7, v1
    v_and_b32 v54, 1, v53
    v_lshlrev_b32 v54, 4, v54
    v_mov_b32 v55, 0x3f80
    v_lshlrev_b32 v54, v54, v55
    v_lshrrev_b32 v55, 1, v53
    v_cmp_eq_u32 vcc, 0, v55
    s_nop 1
    v_cndmask_b32 v184, 0, v54, vcc
    v_cmp_eq_u32 vcc, 1, v55
    s_nop 1
    v_cndmask_b32 v185, 0, v54, vcc
    v_cmp_eq_u32 vcc, 2, v55
    s_nop 1
    buffer_load_dwordx4 v59, s[32:35], s86 offen offset:1024  lds
    v_cndmask_b32 v186, 0, v54, vcc
    v_cmp_eq_u32 vcc, 3, v55
    s_nop 1
    v_cndmask_b32 v187, 0, v54, vcc
    v_lshlrev_b32 v54, 5, v1
    v_and_b32 v2, 31, v0
    v_lshlrev_b32 v63, 2, v63
    s_mov_b64 exec, 0x1ff
    ds_write_b128 v54, v[48:51] offset:304
    s_mov_b64 exec, 0x100
    ds_write_b128 v54, v[48:51] offset:288
    s_mov_b64 exec, 0xff
    ds_write_b128 v54, v[184:187] offset:288
    s_mov_b64 exec, -1
    s_mov_b32 m0, s84
    s_nop 0
    buffer_load_dwordx4 v35, s[44:47], s64 offen lds
    s_add_u32 s24, s20, 1024
    s_addc_u32 s25, s21, 0
    s_mov_b32 s26, 3203072
    s_mov_b32 s27, 0x20000
    s_lshr_b32 s70, s2, 3
    s_mul_i32 s70, s70, 99968
    s_add_u32 s70, s70, 3072
    v_lshl_add_u32 v38, v1, 3, s22
    s_movk_i32 s71, 320
    v_cmp_gt_u32 vcc, s71, v38
    v_lshl_add_u32 v38, v38, 7, s70
    v_mov_b32 v43, 0x7ffffff0
    buffer_load_dwordx4 v35, s[44:47], s64 offen offset:1024 lds
    v_cndmask_b32 v38, v43, v38, vcc
    s_mov_b32 s61, 32
    s_mov_b32 s62, 0
    v_lshrrev_b32 v52, 5, v1
    v_bfe_u32 v53, v1, 2, 2
    v_lshl_add_u32 v52, v52, 3, v53
    v_lshlrev_b32 v36, 8, v52
    v_and_b32 v52, 1, v1
    v_lshlrev_b32 v52, 5, v52
    v_bfe_u32 v54, v1, 1, 1
    v_lshl_add_u32 v52, v54, 3, v52
    v_bfe_u32 v54, v1, 4, 1
    v_lshl_add_u32 v52, v54, 4, v52
    buffer_load_dwordx4 v35, s[44:47], s64 offen offset:2048 lds
    s_and_b32 s70, s22, 3
    s_lshl_b32 s70, s70, 6
    v_add_u32 v52, s70, v52
    v_lshlrev_b32 v53, 6, v53
    v_xor_b32 v52, v52, v53
    v_add_u32 v36, v36, v52
    v_add_u32 v62, 131072, v62
    v_lshrrev_b32 v52, 5, v1
    v_and_b32 v53, 15, v1
    v_xor_b32 v54, v52, v53
    v_lshlrev_b32 v54, 4, v54
    v_lshl_add_u32 v61, v53, 8, v54
    v_bfe_u32 v54, v1, 4, 1
    buffer_load_dwordx4 v35, s[44:47], s64 offen offset:3072 lds
    v_lshl_add_u32 v61, v54, 13, v61
    s_lshr_b32 s70, s22, 2
    s_lshl_b32 s70, s70, 14
    s_add_u32 s70, s70, 98304
    v_add_u32 v61, s70, v61
    s_mov_b32 s28, s6
    s_mov_b32 s29, s7
    s_mov_b32 s30, 12800000
    s_mov_b32 s31, 0x20000
    s_mov_b32 s63, 0
    s_mov_b32 s68, 1
    s_mov_b32 s66, 0x7fffffe0
    v_mov_b32 v14, 544
    v_bfe_u32 v53, v1, 3, 2
    s_mov_b32 m0, s85
    s_nop 0
    buffer_load_dwordx4 v35, s[48:51], s64 offen lds
    v_bfe_u32 v55, v1, 1, 1
    v_lshl_add_u32 v53, v53, 1, v55
    v_lshlrev_b32 v53, 5, v53
    s_mov_b32 exec_lo, 0x0f0f0f0f
    s_mov_b32 exec_hi, 0xf0f0f0f0
    v_add_u32 v14, 288, v53
    s_mov_b64 exec, -1
    v_lshlrev_b32 v16, 4, v52
    v_and_b32 v53, 3, v1
    v_lshlrev_b32 v13, 3, v53
    v_lshl_add_u32 v13, v54, 5, v13
    v_add_u32 v13, 576, v13
    v_lshlrev_b32 v15, 2, v2
    buffer_load_dwordx4 v35, s[48:51], s64 offen offset:1024 lds
    v_mad_u32_u24 v31, v16, 33, v15
    s_mul_i32 s70, s22, 1056
    s_add_u32 s70, s70, 56672
    v_add_u32 v31, s70, v31
    v_lshlrev_b32 v54, 6, v54
    v_sub_u32 v15, v15, v54
    v_add_u32 v15, 29648, v15
    v_bfe_u32 v53, v1, 2, 2
    v_lshl_add_u32 v11, v53, 7, v13
    v_lshl_add_u32 v11, v52, 11, v11
    v_and_b32 v53, 8, v1
    v_lshl_add_u32 v11, v53, 3, v11
    s_add_u32 s70, s65, -320
    buffer_load_dwordx4 v35, s[48:51], s64 offen offset:2048 lds
    v_add_u32 v11, s70, v11
    v_xor_b32 v12, 64, v11
    s_movk_i32 s79, 256
    v_mov_b32 v34, 0
    v_lshrrev_b32 v52, 3, v2
    v_and_b32 v53, 3, v1
    v_lshl_add_u32 v7, v52, 2, v53
    v_lshlrev_b32 v7, 3, v7
    v_bfe_u32 v53, v1, 2, 2
    v_lshlrev_b32 v9, 4, v53
    v_and_b32 v8, 24, v1
    v_and_b32 v52, 7, v1
    v_bfe_u32 v53, v1, 4, 1
    buffer_load_dwordx4 v35, s[48:51], s64 offen offset:3072 lds
    v_lshlrev_b32 v52, 4, v52
    v_lshlrev_b32 v53, 6, v53
    v_xor_b32 v155, v52, v53
    v_add_u32 v152, 3072, v155
    v_add_u32 v153, 2048, v155
    v_add_u32 v154, 1024, v155
    v_mov_b32 v40, 1
    v_mov_b32 v41, 256
    v_lshlrev_b32 v42, 2, v1
    s_mov_b32 s70, 0x420000
    s_brev_b32 s76, 1
    s_add_u32 s77, s62, s61
    v_cmp_ne_u32 s[82:83], 0, v63
    buffer_load_dword v37, v38, s[24:27], 0 offen
    s_waitcnt vmcnt(12)
    v_mov_b32_dpp v3, v160 quad_perm:[0,0,0,0] row_mask:0xf bank_mask:0xf
K2_COUNT:
    v_lshlrev_b32_sdwa v185, 2, v161 dst_sel:BYTE_0 dst_unused:UNUSED_PAD src0_sel:DWORD src1_sel:BYTE_0
    v_min_u32 v4, s77, v3
    v_sub_u32 v4, v4, v63
    v_cmp_lt_u32 s[86:87], s77, v3
    v_cmp_lt_i32 s[80:81], 0, v4
    v_lshlrev_b32_sdwa v184, 2, v160 dst_sel:BYTE_0 dst_unused:UNUSED_PAD src0_sel:DWORD src1_sel:BYTE_0
    v_cmpx_lt_i32 vcc, 1, v4
    v_lshlrev_b32_sdwa v186, 2, v162 dst_sel:BYTE_0 dst_unused:UNUSED_PAD src0_sel:DWORD src1_sel:BYTE_0
    ds_add_rtn_u32 v173, v185, v40 offset:0
    v_cmpx_lt_i32 vcc, 2, v4
    v_lshlrev_b32_sdwa v187, 2, v163 dst_sel:BYTE_0 dst_unused:UNUSED_PAD src0_sel:DWORD src1_sel:BYTE_0
    ds_add_rtn_u32 v174, v186, v40 offset:0
    v_cmpx_lt_i32 vcc, 3, v4
    v_lshlrev_b32_sdwa v188, 2, v164 dst_sel:BYTE_0 dst_unused:UNUSED_PAD src0_sel:DWORD src1_sel:BYTE_0
    ds_add_rtn_u32 v175, v187, v40 offset:0
    v_cmpx_lt_i32 vcc, 16, v4
    v_lshlrev_b32_sdwa v189, 2, v165 dst_sel:BYTE_0 dst_unused:UNUSED_PAD src0_sel:DWORD src1_sel:BYTE_0
    ds_add_rtn_u32 v176, v188, v40 offset:0
    v_cmpx_lt_i32 vcc, 17, v4
    v_lshlrev_b32_sdwa v190, 2, v166 dst_sel:BYTE_0 dst_unused:UNUSED_PAD src0_sel:DWORD src1_sel:BYTE_0
    ds_add_rtn_u32 v177, v189, v40 offset:0
    v_cmpx_lt_i32 vcc, 18, v4
    v_lshlrev_b32_sdwa v191, 2, v167 dst_sel:BYTE_0 dst_unused:UNUSED_PAD src0_sel:DWORD src1_sel:BYTE_0
    ds_add_rtn_u32 v178, v190, v40 offset:0
    v_cmpx_lt_i32 vcc, 19, v4
    ds_add_rtn_u32 v179, v191, v40 offset:0
    s_and_b64 s[80:81], s[80:81], s[82:83]
    s_mov_b64 exec, s[80:81]
    ds_add_rtn_u32 v172, v184, v40 offset:0
    s_mov_b64 exec, s[86:87]
    ds_write_b32 v41, v40
    s_mov_b64 exec, -1
    v_lshrrev_b32 v212, 20, v160
    v_add_lshl_u32 v212, v212, v6, 5
    v_lshrrev_b32 v214, 20, v161
    v_add_lshl_u32 v214, v214, v6, 5
    v_lshrrev_b32 v216, 20, v162
    v_add_lshl_u32 v216, v216, v6, 5
    v_lshrrev_b32 v218, 20, v163
    v_add_lshl_u32 v218, v218, v6, 5
    v_lshrrev_b32 v220, 20, v164
    v_add_lshl_u32 v220, v220, v6, 5
    v_lshrrev_b32 v222, 20, v165
    v_add_lshl_u32 v222, v222, v6, 5
    v_lshrrev_b32 v224, 20, v166
    v_add_lshl_u32 v224, v224, v6, 5
    v_lshrrev_b32 v226, 20, v167
    v_add_lshl_u32 v226, v226, v6, 5
    s_waitcnt lgkmcnt(0)
    s_barrier
    ds_read_b32 v46, v42 offset:0
    ds_read_b32 v45, v41
    v_bfe_u32 v213, v160, 6, 14
    v_mad_u32_u24 v213, v184, s70, v213
    v_bfe_u32 v215, v161, 6, 14
    v_mad_u32_u24 v215, v185, s70, v215
    v_bfe_u32 v217, v162, 6, 14
    v_mad_u32_u24 v217, v186, s70, v217
    v_bfe_u32 v219, v163, 6, 14
    v_mad_u32_u24 v219, v187, s70, v219
    v_bfe_u32 v221, v164, 6, 14
    v_mad_u32_u24 v221, v188, s70, v221
    v_bfe_u32 v223, v165, 6, 14
    v_mad_u32_u24 v223, v189, s70, v223
    v_bfe_u32 v225, v166, 6, 14
    v_mad_u32_u24 v225, v190, s70, v225
    v_bfe_u32 v227, v167, 6, 14
    v_mad_u32_u24 v227, v191, s70, v227
    s_waitcnt lgkmcnt(0)
    v_add_u32 v43, 1, v46
    v_lshrrev_b32 v43, 1, v43
    v_mov_b32 v44, v43
    v_readfirstlane_b32 s67, v45
    v_add_u32 v160, -1, v172
    v_and_or_b32 v212, v160, s76, v212
    v_add_u32_dpp v44, v44, v44 row_shr:1 row_mask:0xf bank_mask:0xf bound_ctrl:0
    v_add_u32 v161, -1, v173
    v_and_or_b32 v214, v161, s76, v214
    v_add_u32_dpp v44, v44, v44 row_shr:2 row_mask:0xf bank_mask:0xf bound_ctrl:0
    v_add_u32 v162, -1, v174
    v_and_or_b32 v216, v162, s76, v216
    v_add_u32_dpp v44, v44, v44 row_shr:4 row_mask:0xf bank_mask:0xf bound_ctrl:0
    v_add_u32 v163, -1, v175
    v_and_or_b32 v218, v163, s76, v218
    v_add_u32_dpp v44, v44, v44 row_shr:8 row_mask:0xf bank_mask:0xf bound_ctrl:0
    v_add_u32 v164, -1, v176
    v_and_or_b32 v220, v164, s76, v220
    v_add_u32_dpp v44, v44, v44 row_bcast:15 row_mask:0xa bank_mask:0xf
    v_add_u32 v165, -1, v177
    v_and_or_b32 v222, v165, s76, v222
    v_add_u32_dpp v44, v44, v44 row_bcast:31 row_mask:0xc bank_mask:0xf
    v_add_u32 v166, -1, v178
    v_readlane_b32 s75, v44, 63
    v_sub_u32 v44, v44, v43
    v_lshlrev_b32 v44, 4, v44
    ds_bpermute_b32 v184, v184, v44
    ds_bpermute_b32 v185, v185, v44
    ds_bpermute_b32 v186, v186, v44
    ds_bpermute_b32 v187, v187, v44
    ds_bpermute_b32 v188, v188, v44
    ds_bpermute_b32 v189, v189, v44
    ds_bpermute_b32 v190, v190, v44
    ds_bpermute_b32 v191, v191, v44
    v_and_or_b32 v224, v166, s76, v224
    v_add_u32 v167, -1, v179
    v_and_or_b32 v226, v167, s76, v226
    s_cmp_gt_u32 s75, 1025
    s_cbranch_scc1 K2_TOOBIG
    s_add_u32 s70, s75, 7
    s_lshr_b32 s70, s70, 3
    s_add_u32 s71, s70, 14
    s_lshr_b32 s71, s71, 4
    s_lshl_b32 s71, s71, 3
    s_min_u32 s71, s71, s70
    s_sub_u32 s72, s70, s71
    s_and_b32 s73, s22, 3
    s_mul_i32 s73, s73, s70
    s_cmp_lt_u32 s22, 4
    s_cselect_b32 s60, s71, s72
    s_cselect_b32 s74, 0, s71
    s_add_u32 s73, s73, s74
    s_lshl_b32 s73, s73, 5
    s_add_u32 s73, s73, 13776
    s_lshl_b32 s74, s60, 4
    s_add_u32 s56, s60, 7
    s_lshr_b32 s56, s56, 3
    s_cmp_eq_u32 s22, 7
    s_cbranch_scc0 K2_NODUM
    v_mov_b32 v48, 0x7ffffff0
    v_mov_b32 v49, 0xffff
    v_mov_b32 v50, 0x7ffffff0
    v_mov_b32 v51, 0xffff
    v_lshl_add_u32 v47, v46, 3, v44
    v_and_b32 v46, 1, v46
    v_cmp_eq_u32 vcc, 1, v46
    s_mov_b64 exec, vcc
    ds_write_b64 v47, v[48:49] offset:13776
    s_mov_b32 exec_lo, -1
    s_mov_b32 exec_hi, 0x7f
    v_add_lshl_u32 v47, v1, s75, 4
    ds_write_b128 v47, v[48:51] offset:13776
    s_mov_b64 exec, -1
K2_NODUM:
    s_waitcnt lgkmcnt(0)
    v_lshl_add_u32 v184, v172, 3, v184
    v_cmpx_lt_i32 vcc, 1, v4
    v_lshl_add_u32 v185, v173, 3, v185
    ds_write_b64 v185, v[214:215] offset:13776
    v_cmpx_lt_i32 vcc, 2, v4
    v_lshl_add_u32 v186, v174, 3, v186
    ds_write_b64 v186, v[216:217] offset:13776
    v_cmpx_lt_i32 vcc, 3, v4
    v_lshl_add_u32 v187, v175, 3, v187
    ds_write_b64 v187, v[218:219] offset:13776
    v_cmpx_lt_i32 vcc, 16, v4
    v_lshl_add_u32 v188, v176, 3, v188
    ds_write_b64 v188, v[220:221] offset:13776
    v_cmpx_lt_i32 vcc, 17, v4
    v_lshl_add_u32 v189, v177, 3, v189
    ds_write_b64 v189, v[222:223] offset:13776
    v_cmpx_lt_i32 vcc, 18, v4
    v_lshl_add_u32 v190, v178, 3, v190
    ds_write_b64 v190, v[224:225] offset:13776
    v_cmpx_lt_i32 vcc, 19, v4
    v_lshl_add_u32 v191, v179, 3, v191
    ds_write_b64 v191, v[226:227] offset:13776
    s_mov_b64 exec, s[80:81]
    ds_write_b64 v184, v[212:213] offset:13776
    s_mov_b64 exec, -1
    v_add_u32 v7, s73, v7
    v_add3_u32 v8, v8, s73, 4
    v_add3_u32 v9, v9, s73, 6
    s_mov_b32 exec_lo, 0xf0f0f0f0
    s_mov_b32 exec_hi, 0xf0f0f0f0
    v_add_u32 v7, s74, v7
    s_mov_b32 exec_lo, 0
    s_mov_b32 exec_hi, -1
    v_add_u32 v8, s74, v8
    v_add_u32 v9, s74, v9
    s_mov_b64 exec, -1
    s_sub_u32 s71, s71, 1
    s_sub_u32 s72, s72, 1
    s_min_u32 s71, s71, s72
    v_cmp_lt_u32 s[88:89], s71, v43
    s_cmp_eq_u32 s56, 0
    s_cselect_b32 s26, 0, 3203072
    s_cselect_b32 s30, 0, 12800000
    s_cmp_eq_u32 s68, 0
    s_waitcnt vmcnt(1) lgkmcnt(0)
    s_barrier
    s_cbranch_scc1 K2_PRO2
    ds_read_b32 v30, v7 offset:0
    ds_read2_b32 v[148:149], v8 offset0:0 offset1:8
    ds_read2_b32 v[150:151], v8 offset0:16 offset1:24
    ds_read_u16 v28, v9 offset:0
    ds_read_u16 v29, v9 offset:64
    ds_read_b128 v[64:67], v61
    v_xor_b32 v41, 32, v61
    ds_read_b128 v[68:71], v41
    v_xor_b32 v40, 64, v61
    ds_read_b128 v[72:75], v40
    v_xor_b32 v41, 96, v61
    ds_read_b128 v[76:79], v41
    v_xor_b32 v40, 128, v61
    ds_read_b128 v[80:83], v40
    v_xor_b32 v41, 160, v61
    ds_read_b128 v[84:87], v41
    v_xor_b32 v40, 192, v61
    ds_read_b128 v[88:91], v40
    v_xor_b32 v41, 224, v61
    ds_read_b128 v[92:95], v41
    s_waitcnt lgkmcnt(8)
    v_mad_u32_u16 v144, v148, s79, v152
    v_mad_u32_u16 v145, v149, s79, v153
    v_mad_u32_u16 v146, v150, s79, v154
    v_mad_u32_u16 v147, v151, s79, v155
    v_and_or_b32 v20, v30, s66, v16
    v_and_or_b32 v21, v30, 16, v14
    v_cmp_gt_i32 vcc, 0, v30
    v_add_u32 v22, v28, v13
    v_add_u32 v23, v29, v13
    ds_read_b32 v30, v7 offset:128
    ds_read2_b32 v[148:149], v8 offset0:32 offset1:40
    ds_read2_b32 v[150:151], v8 offset0:48 offset1:56
    s_lshr_b32 s33, vcc_lo, 4
    s_mov_b32 s32, vcc_lo
    s_or_b32 s33, s33, vcc_lo
    s_or_b32 s33, s33, s63
    v_add_u32 v43, 102400, v36
    s_add_u32 m0, s64, 65536
    s_nop 0
    buffer_load_dwordx4 v144, s[24:27], 0 offen  lds
    ds_read_b64_tr_b16 v[128:129], v43 offset:0
    ds_read_b64_tr_b16 v[130:131], v43 offset:1024
    ds_read_b64_tr_b16 v[132:133], v43 offset:8192
    ds_read_b64_tr_b16 v[134:135], v43 offset:9216
    ds_read_b64_tr_b16 v[136:137], v43 offset:16384
    ds_read_b64_tr_b16 v[138:139], v43 offset:17408
    ds_read_b64_tr_b16 v[140:141], v43 offset:24576
    ds_read_b64_tr_b16 v[142:143], v43 offset:25600
    ds_read_b64_tr_b16 v[160:161], v43 offset:32768
    buffer_load_dwordx4 v145, s[24:27], 0 offen offset:1024  lds
    ds_read_b64_tr_b16 v[162:163], v43 offset:33792
    ds_read_b64_tr_b16 v[164:165], v43 offset:40960
    ds_read_b64_tr_b16 v[166:167], v43 offset:41984
    ds_read_b64_tr_b16 v[168:169], v43 offset:49152
    ds_read_b64_tr_b16 v[170:171], v43 offset:50176
    ds_read_b64_tr_b16 v[172:173], v43 offset:57344
    ds_read_b64_tr_b16 v[174:175], v43 offset:58368
    ds_read_b64_tr_b16 v[96:97], v36 offset:32768
    ds_read_b64_tr_b16 v[98:99], v36 offset:33792
    buffer_load_dwordx4 v[176:179], v20, s[28:31], 0 offen
    ds_read_b64_tr_b16 v[100:101], v36 offset:36864
    ds_read_b64_tr_b16 v[102:103], v36 offset:37888
    ds_read_b64_tr_b16 v[104:105], v36 offset:40960
    ds_read_b64_tr_b16 v[106:107], v36 offset:41984
    ds_read_b64_tr_b16 v[108:109], v36 offset:45056
    ds_read_b64_tr_b16 v[110:111], v36 offset:46080
    ds_read_b64_tr_b16 v[112:113], v36 offset:49152
    ds_read_b64_tr_b16 v[114:115], v36 offset:50176
    ds_read_b64_tr_b16 v[116:117], v36 offset:53248
    v_cmp_ne_u32 vcc, v21, v14
    v_mov_b32_dpp v17, v22 row_newbcast:0 row_mask:0xf bank_mask:0xf
    v_mov_b32 v60, v21
    buffer_load_dwordx4 v146, s[24:27], 0 offen offset:2048  lds
    ds_read_b64_tr_b16 v[118:119], v36 offset:54272
    ds_read_b64_tr_b16 v[120:121], v36 offset:57344
    ds_read_b64_tr_b16 v[122:123], v36 offset:58368
    ds_read_b64_tr_b16 v[124:125], v36 offset:61440
    ds_read_b64_tr_b16 v[126:127], v36 offset:62464
    ds_read_b128 v[196:199], v62 offset:0
    ds_read_b128 v[200:203], v62 offset:1024
    ds_read_b128 v[204:207], v62 offset:2048
    ds_read_b128 v[208:211], v62 offset:3072
    s_cmp_eq_u32 s56, 0
    s_cselect_b32 s69, -1, vcc_lo
    v_lshl_add_u32 v17, v17, 1, v15
    buffer_load_dwordx4 v147, s[24:27], 0 offen offset:3072  lds
    s_lshr_b32 s71, s22, 2
    s_lshl_b32 s71, s71, 5
    v_add_u32 v41, s71, v2
    v_mul_u32_u24 v42, 264, v41
    v_lshl_add_u32 v42, v16, 1, v42
    s_and_b32 s71, s22, 3
    s_lshl_b32 s71, s71, 6
    v_add_u32 v42, s71, v42
    v_cmp_gt_u32 s[80:81], 49, v41
    v_lshlrev_b32 v40, 4, v0
    v_mov_b32 v48, 0
    v_mov_b32 v49, 0
    v_mov_b32 v50, 0
    v_mov_b32 v51, 0
    s_movk_i32 s71, 81
    v_cmp_gt_u32 s[82:83], s71, v0
    s_mov_b32 s70, 0xbfb8aa3b
    s_mov_b32 s71, 0xbfb8aa3b
    s_waitcnt lgkmcnt(0)
    v_mfma_f32_32x32x16_bf16 v[212:227], v[128:131], v[64:67], 0
    v_mfma_f32_32x32x16_bf16 v[212:227], v[132:135], v[68:71], v[212:227]
    v_mfma_f32_32x32x16_bf16 v[212:227], v[136:139], v[72:75], v[212:227]
    v_mfma_f32_32x32x16_bf16 v[212:227], v[140:143], v[76:79], v[212:227]
    v_mfma_f32_32x32x16_bf16 v[212:227], v[160:163], v[80:83], v[212:227]
    v_mfma_f32_32x32x16_bf16 v[212:227], v[164:167], v[84:87], v[212:227]
    v_mfma_f32_32x32x16_bf16 v[212:227], v[168:171], v[88:91], v[212:227]
    v_mfma_f32_32x32x16_bf16 v[212:227], v[172:175], v[92:95], v[212:227]
    v_mfma_f32_32x32x16_bf16 v[236:251], v[96:99], v[64:67], 0
    s_nop 9
    v_mfma_f32_32x32x16_bf16 v[236:251], v[100:103], v[68:71], v[236:251]
    v_mul_f32 v212, s70, v212
    v_mul_f32 v213, s70, v213
    v_mul_f32 v214, s70, v214
    v_mul_f32 v215, s70, v215
    v_mul_f32 v216, s70, v216
    v_mul_f32 v217, s70, v217
    v_mul_f32 v218, s70, v218
    v_mul_f32 v219, s70, v219
    v_mfma_f32_32x32x16_bf16 v[236:251], v[104:107], v[72:75], v[236:251]
    v_mul_f32 v220, s70, v220
    v_mul_f32 v221, s70, v221
    v_mul_f32 v222, s70, v222
    v_mul_f32 v223, s70, v223
    v_mul_f32 v224, s70, v224
    v_mul_f32 v225, s70, v225
    v_mul_f32 v226, s70, v226
    v_mul_f32 v227, s70, v227
    v_mfma_f32_32x32x16_bf16 v[236:251], v[108:111], v[76:79], v[236:251]
    v_cvt_pk_bf16_f32 v212, v212, v213
    v_cvt_pk_bf16_f32 v213, v214, v215
    v_cvt_pk_bf16_f32 v214, v216, v217
    v_cvt_pk_bf16_f32 v215, v218, v219
    v_cvt_pk_bf16_f32 v216, v220, v221
    v_cvt_pk_bf16_f32 v217, v222, v223
    v_cvt_pk_bf16_f32 v218, v224, v225
    v_cvt_pk_bf16_f32 v219, v226, v227
    s_mov_b64 exec, s[80:81]
    ds_write_b64 v42, v[212:213] offset:576
    ds_write_b64 v42, v[214:215] offset:584
    ds_write_b64 v42, v[216:217] offset:592
    ds_write_b64 v42, v[218:219] offset:600
    s_mov_b64 exec, -1
    s_barrier
    ds_write_b128 v40, v[48:51] offset:30800
    ds_write_b128 v40, v[48:51] offset:38992
    ds_write_b128 v40, v[48:51] offset:47184
    v_mfma_f32_32x32x16_bf16 v[236:251], v[112:115], v[80:83], v[236:251]
    s_mov_b64 exec, s[82:83]
    ds_write_b128 v40, v[48:51] offset:55376
    s_mov_b64 exec, -1
    s_add_u32 m0, s65, 4224
    s_nop 0
    buffer_load_dwordx4 v144, s[24:27], 0 offen offset:128  lds
    v_mfma_f32_32x32x16_bf16 v[236:251], v[116:119], v[84:87], v[236:251]
    s_waitcnt lgkmcnt(0)
    s_barrier
    buffer_load_dwordx4 v145, s[24:27], 0 offen offset:1152  lds
    v_mfma_f32_32x32x16_bf16 v[236:251], v[120:123], v[88:91], v[236:251]
    buffer_load_dwordx4 v146, s[24:27], 0 offen offset:2176  lds
    v_mfma_f32_32x32x16_bf16 v[236:251], v[124:127], v[92:95], v[236:251]
    buffer_load_dwordx4 v147, s[24:27], 0 offen offset:3200  lds
    s_cmp_lt_u32 s56, 2
    s_cselect_b32 s26, 0, s26
    s_cselect_b32 s30, 0, s30
    v_mad_u32_u16 v144, v148, s79, v152
    v_mad_u32_u16 v145, v149, s79, v153
    v_mad_u32_u16 v146, v150, s79, v154
    v_mad_u32_u16 v147, v151, s79, v155
    v_and_or_b32 v20, v30, s66, v16
    v_and_or_b32 v21, v30, 16, v14
    v_cmp_gt_i32 vcc, 0, v30
    ds_read_b32 v30, v7 offset:256
    ds_read2_b32 v[148:149], v8 offset0:64 offset1:72
    ds_read2_b32 v[150:151], v8 offset0:80 offset1:88
    ds_read_u16 v28, v9 offset:128
    ds_read_u16 v29, v9 offset:192
    s_lshr_b32 s35, vcc_lo, 4
    s_mov_b32 s34, vcc_lo
    s_or_b32 s35, s35, vcc_lo
    s_or_b32 s35, s35, s63
    v_pk_mul_f32 v[236:237], v[236:237], s[70:71]
    v_pk_mul_f32 v[238:239], v[238:239], s[70:71]
    v_pk_mul_f32 v[240:241], v[240:241], s[70:71]
    v_pk_mul_f32 v[242:243], v[242:243], s[70:71]
    v_pk_mul_f32 v[244:245], v[244:245], s[70:71]
    v_pk_mul_f32 v[246:247], v[246:247], s[70:71]
    v_pk_mul_f32 v[248:249], v[248:249], s[70:71]
    v_pk_mul_f32 v[250:251], v[250:251], s[70:71]
K2_NOX:
    s_cmp_eq_u32 s56, 0
    s_cbranch_scc1 K2_NOTILES
    ds_read_b128 v[184:187], v60
    ds_read_b64_tr_b16 v[168:169], v22 offset:0
    ds_read_b64_tr_b16 v[170:171], v23 offset:0
    ds_read_b64_tr_b16 v[172:173], v22 offset:64
    ds_read_b64_tr_b16 v[174:175], v23 offset:64
    ds_read_b64_tr_b16 v[160:161], v22 offset:128
    ds_read_b64_tr_b16 v[162:163], v23 offset:128
    ds_read_b64_tr_b16 v[164:165], v22 offset:192
    ds_read_b64_tr_b16 v[166:167], v23 offset:192
    buffer_load_dwordx4 v[180:183], v20, s[28:31], 0 offen
    s_add_u32 m0, s65, 256
    s_nop 0
    buffer_load_dwordx4 v144, s[24:27], 0 offen  lds
    buffer_load_dwordx4 v145, s[24:27], 0 offen offset:1024  lds
    buffer_load_dwordx4 v146, s[24:27], 0 offen offset:2048  lds
    buffer_load_dwordx4 v147, s[24:27], 0 offen offset:3072  lds
    v_mov_b32 v188, 0
    v_mov_b32 v189, 0
    v_mov_b32 v190, 0
    v_mov_b32 v191, 0
    s_mov_b32 exec_lo, 0xf
    s_mov_b32 exec_hi, 0xf00
    v_mov_b32 v188, 0x3f80
    s_mov_b32 exec_lo, 0xf0
    s_mov_b32 exec_hi, 0xf000
    v_mov_b32 v189, 0x3f80
    s_mov_b32 exec_lo, 0xf0000
    s_mov_b32 exec_hi, 0xf000000
    v_mov_b32 v190, 0x3f80
    s_mov_b32 exec_lo, 0xf00000
    s_mov_b32 exec_hi, 0xf0000000
    v_mov_b32 v191, 0x3f80
    s_mov_b64 exec, -1
    v_and_b32 v192, 3, v1
    v_mul_u32_u24 v192, 0x5555, v192
    s_add_u32 s58, s65, 4224
    s_add_u32 s59, s65, 256
    s_and_b32 s70, s60, 6
    s_and_b32 s71, s60, 1
    s_lshl1_add_u32 s70, s70, s71
    s_lshl_b32 s70, s70, 1
    s_cselect_b32 s71, 1, 0
    s_lshl_b32 s53, s71, s70
    s_lshl_b32 s52, s53, 1
    s_cmp_eq_u32 s56, 1
    s_cselect_b64 s[70:71], s[52:53], 0
    s_or_b64 s[32:33], s[32:33], s[70:71]
    v_mov_b32 v212, 0
    v_mov_b32 v213, 0
    v_mov_b32 v220, 1.0
    v_mov_b32 v221, 1.0
    v_mov_b32 v214, 0
    v_mov_b32 v215, 0
    v_mov_b32 v222, 1.0
    v_mov_b32 v223, 1.0
    v_mov_b32 v216, 0
    v_mov_b32 v217, 0
    v_mov_b32 v224, 1.0
    v_mov_b32 v225, 1.0
    v_mov_b32 v218, 0
    v_mov_b32 v219, 0
    v_mov_b32 v226, 1.0
    v_mov_b32 v227, 1.0
    v_mov_b32 v32, v31
    v_mov_b32 v33, v31
    v_mov_b32 v156, 0
    v_mov_b32 v157, 0
    v_mov_b32 v158, 0
    v_mov_b32 v159, 0
    s_sub_u32 s70, s64, s65
    s_add_u32 s70, s70, 65280
    v_add_u32 v40, s70, v11
    v_add_u32 v41, s70, v12
    s_waitcnt vmcnt(9)
    ds_read_b64_tr_b16 v[128:129], v40 offset:0
    ds_read_b64_tr_b16 v[130:131], v40 offset:512
    ds_read_b64_tr_b16 v[132:133], v40 offset:1024
    ds_read_b64_tr_b16 v[134:135], v40 offset:1536
    ds_read_b64_tr_b16 v[136:137], v41 offset:0
    ds_read_b64_tr_b16 v[138:139], v41 offset:512
    ds_read_b64_tr_b16 v[140:141], v41 offset:1024
    ds_read_b64_tr_b16 v[142:143], v41 offset:1536
    s_waitcnt lgkmcnt(8)
    v_mfma_f32_32x32x16_bf16 v[64:79], v[176:179], v[196:199], 0
    v_mfma_f32_32x32x16_bf16 v[80:95], v[176:179], v[200:203], 0
    v_mfma_f32_32x32x16_bf16 v[64:79], v[184:187], v[168:171], v[64:79]
    v_mfma_f32_32x32x16_bf16 v[80:95], v[184:187], v[172:175], v[80:95]
    s_waitcnt lgkmcnt(0)
    v_smfmac_f32_32x32x32_bf16 v[64:79], v[188:191], v[128:135], v192
    v_smfmac_f32_32x32x32_bf16 v[80:95], v[188:191], v[136:143], v192
    s_sub_u32 s57, s56, 1
    s_waitcnt vmcnt(5)
    ds_read_b64_tr_b16 v[128:129], v11 offset:4096
    ds_read_b64_tr_b16 v[130:131], v11 offset:4608
    ds_read_b64_tr_b16 v[132:133], v11 offset:5120
    ds_read_b64_tr_b16 v[134:135], v11 offset:5632
    ds_read_b64_tr_b16 v[136:137], v12 offset:4096
    ds_read_b64_tr_b16 v[138:139], v12 offset:4608
    ds_read_b64_tr_b16 v[140:141], v12 offset:5120
    ds_read_b64_tr_b16 v[142:143], v12 offset:5632
    s_nop 0
K2_LOOP:
    s_setprio 1
    v_mfma_f32_32x32x16_bf16 v[96:111], v[176:179], v[204:207], 0
    v_exp_f32 v228, v64
    v_exp_f32 v229, v65
    v_exp_f32 v230, v80
    v_exp_f32 v231, v81
    v_add_u32 v24, v28, v13
    v_add_u32_e64 v25, v29, v13
    s_bitcmp1_b32 s33, 0
    s_cbranch_scc1 F_A0_0
    v_pk_fma_f32 v[232:233], v[64:65], v[220:221], v[212:213]
    v_pk_fma_f32 v[234:235], v[80:81], v[222:223], v[214:215]
    v_pk_fma_f32 v[220:221], v[220:221], v[228:229], v[220:221]
    v_pk_fma_f32 v[222:223], v[222:223], v[230:231], v[222:223]
    v_pk_fma_f32 v[212:213], v[212:213], v[228:229], v[232:233]
    v_pk_fma_f32 v[214:215], v[214:215], v[230:231], v[234:235]
R_A0_0:
    v_mfma_f32_32x32x16_bf16 v[112:127], v[176:179], v[208:211], 0
    v_exp_f32 v228, v66
    v_exp_f32 v229, v67
    v_exp_f32 v230, v82
    v_exp_f32 v231, v83
    ds_read_b64_tr_b16 v[168:169], v24 offset:0
    ds_read_b64_tr_b16 v[170:171], v25 offset:0
    ds_read_b64_tr_b16 v[172:173], v24 offset:64
    ds_read_b64_tr_b16 v[174:175], v25 offset:64
    s_bitcmp1_b32 s33, 2
    s_cbranch_scc1 F_A0_1
    v_pk_fma_f32 v[232:233], v[66:67], v[220:221], v[212:213]
    v_pk_fma_f32 v[234:235], v[82:83], v[222:223], v[214:215]
    v_pk_fma_f32 v[220:221], v[220:221], v[228:229], v[220:221]
    v_pk_fma_f32 v[222:223], v[222:223], v[230:231], v[222:223]
    v_pk_fma_f32 v[212:213], v[212:213], v[228:229], v[232:233]
    v_pk_fma_f32 v[214:215], v[214:215], v[230:231], v[234:235]
R_A0_1:
    v_mfma_f32_32x32x16_bf16 v[96:111], v[184:187], v[160:163], v[96:111]
    v_exp_f32 v228, v68
    v_exp_f32 v229, v69
    v_exp_f32 v230, v84
    v_exp_f32 v231, v85
    s_mov_b32 m0, s58
    s_waitcnt lgkmcnt(4)
    buffer_load_dwordx4 v144, s[24:27], 0 offen offset:128  lds
    buffer_load_dwordx4 v145, s[24:27], 0 offen offset:1152  lds
    s_bitcmp1_b32 s33, 8
    s_cbranch_scc1 F_A0_2
    v_pk_fma_f32 v[232:233], v[68:69], v[220:221], v[212:213]
    v_pk_fma_f32 v[234:235], v[84:85], v[222:223], v[214:215]
    v_pk_fma_f32 v[220:221], v[220:221], v[228:229], v[220:221]
    v_pk_fma_f32 v[222:223], v[222:223], v[230:231], v[222:223]
    v_pk_fma_f32 v[212:213], v[212:213], v[228:229], v[232:233]
    v_pk_fma_f32 v[214:215], v[214:215], v[230:231], v[234:235]
R_A0_2:
    v_mfma_f32_32x32x16_bf16 v[112:127], v[184:187], v[164:167], v[112:127]
    v_exp_f32 v228, v70
    v_exp_f32 v229, v71
    v_exp_f32 v230, v86
    v_exp_f32 v231, v87
    buffer_load_dwordx4 v146, s[24:27], 0 offen offset:2176  lds
    buffer_load_dwordx4 v147, s[24:27], 0 offen offset:3200  lds
    s_bitcmp1_b32 s33, 10
    s_cbranch_scc1 F_A0_3
    v_pk_fma_f32 v[232:233], v[70:71], v[220:221], v[212:213]
    v_pk_fma_f32 v[234:235], v[86:87], v[222:223], v[214:215]
    v_pk_fma_f32 v[220:221], v[220:221], v[228:229], v[220:221]
    v_pk_fma_f32 v[222:223], v[222:223], v[230:231], v[222:223]
    v_pk_fma_f32 v[212:213], v[212:213], v[228:229], v[232:233]
    v_pk_fma_f32 v[214:215], v[214:215], v[230:231], v[234:235]
R_A0_3:
    v_smfmac_f32_32x32x32_bf16 v[96:111], v[188:191], v[128:135], v192
    v_exp_f32 v228, v72
    v_exp_f32 v229, v73
    v_exp_f32 v230, v88
    v_exp_f32 v231, v89
    ds_read_b128 v[184:187], v21
    s_cmp_lt_u32 s57, 2
    s_cbranch_scc1 WU2_0
WU2R_0:
    s_bitcmp1_b32 s33, 16
    s_cbranch_scc1 F_A0_4
    v_pk_fma_f32 v[232:233], v[72:73], v[220:221], v[212:213]
    v_pk_fma_f32 v[234:235], v[88:89], v[222:223], v[214:215]
    v_pk_fma_f32 v[220:221], v[220:221], v[228:229], v[220:221]
    v_pk_fma_f32 v[222:223], v[222:223], v[230:231], v[222:223]
    v_pk_fma_f32 v[212:213], v[212:213], v[228:229], v[232:233]
    v_pk_fma_f32 v[214:215], v[214:215], v[230:231], v[234:235]
R_A0_4:
    v_smfmac_f32_32x32x32_bf16 v[112:127], v[188:191], v[136:143], v192
    v_exp_f32 v228, v74
    v_exp_f32 v229, v75
    v_exp_f32 v230, v90
    v_exp_f32 v231, v91
    s_bitcmp1_b32 s33, 18
    s_cbranch_scc1 F_A0_5
    v_pk_fma_f32 v[232:233], v[74:75], v[220:221], v[212:213]
    v_pk_fma_f32 v[234:235], v[90:91], v[222:223], v[214:215]
    v_pk_fma_f32 v[220:221], v[220:221], v[228:229], v[220:221]
    v_pk_fma_f32 v[222:223], v[222:223], v[230:231], v[222:223]
    v_pk_fma_f32 v[212:213], v[212:213], v[228:229], v[232:233]
    v_pk_fma_f32 v[214:215], v[214:215], v[230:231], v[234:235]
R_A0_5:
    v_exp_f32 v228, v76
    v_exp_f32 v229, v77
    v_exp_f32 v230, v92
    v_exp_f32 v231, v93
    s_bitcmp1_b32 s33, 24
    s_cbranch_scc1 F_A0_6
    v_pk_fma_f32 v[232:233], v[76:77], v[220:221], v[212:213]
    v_pk_fma_f32 v[234:235], v[92:93], v[222:223], v[214:215]
    v_pk_fma_f32 v[220:221], v[220:221], v[228:229], v[220:221]
    v_pk_fma_f32 v[222:223], v[222:223], v[230:231], v[222:223]
    v_pk_fma_f32 v[212:213], v[212:213], v[228:229], v[232:233]
    v_pk_fma_f32 v[214:215], v[214:215], v[230:231], v[234:235]
R_A0_6:
    v_exp_f32 v228, v78
    v_exp_f32 v229, v79
    v_exp_f32_e64 v230, v94
    v_exp_f32 v231, v95
    s_waitcnt vmcnt(4) lgkmcnt(0)
    ds_read_b64_tr_b16 v[128:129], v11 offset:0
    ds_read_b64_tr_b16 v[130:131], v11 offset:512
    ds_read_b64_tr_b16 v[132:133], v11 offset:1024
    ds_read_b64_tr_b16 v[134:135], v11 offset:1536
    ds_read_b64_tr_b16 v[136:137], v12 offset:0
    ds_read_b64_tr_b16 v[138:139], v12 offset:512
    ds_read_b64_tr_b16 v[140:141], v12 offset:1024
    ds_read_b64_tr_b16 v[142:143], v12 offset:1536
    s_bitcmp1_b32 s33, 26
    s_cbranch_scc1 F_A0_7
    v_pk_fma_f32 v[232:233], v[78:79], v[220:221], v[212:213]
    v_pk_fma_f32 v[234:235], v[94:95], v[222:223], v[214:215]
    v_pk_fma_f32 v[220:221], v[220:221], v[228:229], v[220:221]
    v_pk_fma_f32 v[222:223], v[222:223], v[230:231], v[222:223]
    v_pk_fma_f32 v[212:213], v[212:213], v[228:229], v[232:233]
    v_pk_fma_f32 v[214:215], v[214:215], v[230:231], v[234:235]
R_A0_7:
    v_mfma_f32_32x32x16_bf16 v[64:79], v[180:183], v[196:199], 0
    v_exp_f32 v228, v96
    v_exp_f32 v229, v97
    v_exp_f32 v230, v112
    v_exp_f32 v231, v113
    ds_read_b64_tr_b16 v[160:161], v24 offset:128
    ds_read_b64_tr_b16 v[162:163], v25 offset:128
    ds_read_b64_tr_b16 v[164:165], v24 offset:192
    ds_read_b64_tr_b16 v[166:167], v25 offset:192
    s_bitcmp1_b32 s33, 0
    s_cbranch_scc1 F_B0_0
    v_pk_fma_f32 v[232:233], v[96:97], v[224:225], v[216:217]
    v_pk_fma_f32 v[234:235], v[112:113], v[226:227], v[218:219]
    v_pk_fma_f32 v[224:225], v[224:225], v[228:229], v[224:225]
    v_pk_fma_f32 v[226:227], v[226:227], v[230:231], v[226:227]
    v_pk_fma_f32 v[216:217], v[216:217], v[228:229], v[232:233]
    v_pk_fma_f32 v[218:219], v[218:219], v[230:231], v[234:235]
R_B0_0:
    v_mfma_f32_32x32x16_bf16 v[80:95], v[180:183], v[200:203], 0
    v_exp_f32 v228, v98
    v_exp_f32 v229, v99
    v_exp_f32 v230, v114
    v_exp_f32 v231, v115
    v_mad_u32_u16 v144, v148, s79, v152
    v_mad_u32_u16 v145, v149, s79, v153
    v_mad_u32_u16 v146, v150, s79, v154
    v_mad_u32_u16 v147, v151, s79, v155
    v_and_or_b32 v20, v30, s66, v16
    v_and_or_b32 v21, v30, 16, v14
    v_cmp_gt_i32_e64 vcc, 0, v30
    s_bitcmp1_b32 s33, 2
    s_cbranch_scc1 F_B0_1
    v_pk_fma_f32 v[232:233], v[98:99], v[224:225], v[216:217]
    v_pk_fma_f32 v[234:235], v[114:115], v[226:227], v[218:219]
    v_pk_fma_f32 v[224:225], v[224:225], v[228:229], v[224:225]
    v_pk_fma_f32 v[226:227], v[226:227], v[230:231], v[226:227]
    v_pk_fma_f32 v[216:217], v[216:217], v[228:229], v[232:233]
    v_pk_fma_f32 v[218:219], v[218:219], v[230:231], v[234:235]
R_B0_1:
    v_mfma_f32_32x32x16_bf16 v[64:79], v[184:187], v[168:171], v[64:79]
    v_exp_f32 v228, v100
    v_exp_f32 v229, v101
    v_exp_f32 v230, v116
    v_exp_f32 v231, v117
    s_mov_b32 m0, s59
    s_waitcnt lgkmcnt(4)
    buffer_load_dwordx4 v144, s[24:27], 0 offen  lds
    buffer_load_dwordx4 v145, s[24:27], 0 offen offset:1024  lds
    s_bitcmp1_b32 s33, 8
    s_cbranch_scc1 F_B0_2
    v_pk_fma_f32 v[232:233], v[100:101], v[224:225], v[216:217]
    v_pk_fma_f32 v[234:235], v[116:117], v[226:227], v[218:219]
    v_pk_fma_f32 v[224:225], v[224:225], v[228:229], v[224:225]
    v_pk_fma_f32 v[226:227], v[226:227], v[230:231], v[226:227]
    v_pk_fma_f32 v[216:217], v[216:217], v[228:229], v[232:233]
    v_pk_fma_f32 v[218:219], v[218:219], v[230:231], v[234:235]
R_B0_2:
    v_mfma_f32_32x32x16_bf16 v[80:95], v[184:187], v[172:175], v[80:95]
    v_exp_f32 v228, v102
    v_exp_f32 v229, v103
    v_exp_f32 v230, v118
    v_exp_f32 v231, v119
    buffer_load_dwordx4 v146, s[24:27], 0 offen offset:2048  lds
    buffer_load_dwordx4 v147, s[24:27], 0 offen offset:3072  lds
    buffer_load_dwordx4 v[176:179], v20, s[28:31], 0 offen
    s_bitcmp1_b32 s33, 10
    s_cbranch_scc1 F_B0_3
    v_pk_fma_f32 v[232:233], v[102:103], v[224:225], v[216:217]
    v_pk_fma_f32 v[234:235], v[118:119], v[226:227], v[218:219]
    v_pk_fma_f32 v[224:225], v[224:225], v[228:229], v[224:225]
    v_pk_fma_f32 v[226:227], v[226:227], v[230:231], v[226:227]
    v_pk_fma_f32 v[216:217], v[216:217], v[228:229], v[232:233]
    v_pk_fma_f32 v[218:219], v[218:219], v[230:231], v[234:235]
R_B0_3:
    v_smfmac_f32_32x32x32_bf16 v[64:79], v[188:191], v[128:135], v192
    v_exp_f32 v228, v104
    v_exp_f32 v229, v105
    v_exp_f32 v230, v120
    v_exp_f32 v231, v121
    ds_read_b32 v30, v7 offset:384
    ds_read2_b32 v[148:149], v8 offset0:96 offset1:104
    ds_read2_b32 v[150:151], v8 offset0:112 offset1:120
    ds_read_u16 v28, v9 offset:256
    ds_read_u16 v29, v9 offset:320
    s_bitcmp1_b32 s33, 16
    s_cbranch_scc1 F_B0_4
    v_pk_fma_f32 v[232:233], v[104:105], v[224:225], v[216:217]
    v_pk_fma_f32 v[234:235], v[120:121], v[226:227], v[218:219]
    v_pk_fma_f32 v[224:225], v[224:225], v[228:229], v[224:225]
    v_pk_fma_f32 v[226:227], v[226:227], v[230:231], v[226:227]
    v_pk_fma_f32 v[216:217], v[216:217], v[228:229], v[232:233]
    v_pk_fma_f32 v[218:219], v[218:219], v[230:231], v[234:235]
R_B0_4:
    v_smfmac_f32_32x32x32_bf16 v[80:95], v[188:191], v[136:143], v192
    v_exp_f32 v228, v106
    v_exp_f32 v229, v107
    v_exp_f32 v230, v122
    v_exp_f32 v231, v123
    s_bitcmp1_b32 s33, 18
    s_cbranch_scc1 F_B0_5
    v_pk_fma_f32 v[232:233], v[106:107], v[224:225], v[216:217]
    v_pk_fma_f32 v[234:235], v[122:123], v[226:227], v[218:219]
    v_pk_fma_f32 v[224:225], v[224:225], v[228:229], v[224:225]
    v_pk_fma_f32 v[226:227], v[226:227], v[230:231], v[226:227]
    v_pk_fma_f32 v[216:217], v[216:217], v[228:229], v[232:233]
    v_pk_fma_f32 v[218:219], v[218:219], v[230:231], v[234:235]
R_B0_5:
    v_exp_f32 v228, v108
    v_exp_f32 v229, v109
    v_exp_f32 v230, v124
    v_exp_f32 v231, v125
    s_bitcmp1_b32 s33, 24
    s_cbranch_scc1 F_B0_6
    v_pk_fma_f32 v[232:233], v[108:109], v[224:225], v[216:217]
    v_pk_fma_f32 v[234:235], v[124:125], v[226:227], v[218:219]
    v_pk_fma_f32 v[224:225], v[224:225], v[228:229], v[224:225]
    v_pk_fma_f32 v[226:227], v[226:227], v[230:231], v[226:227]
    v_pk_fma_f32 v[216:217], v[216:217], v[228:229], v[232:233]
    v_pk_fma_f32 v[218:219], v[218:219], v[230:231], v[234:235]
R_B0_6:
    v_exp_f32 v228, v110
    v_exp_f32 v229, v111
    v_exp_f32_e64 v230, v126
    v_exp_f32 v231, v127
    s_waitcnt vmcnt(5) lgkmcnt(0)
    ds_read_b64_tr_b16 v[128:129], v11 offset:4096
    ds_read_b64_tr_b16 v[130:131], v11 offset:4608
    ds_read_b64_tr_b16 v[132:133], v11 offset:5120
    ds_read_b64_tr_b16 v[134:135], v11 offset:5632
    ds_read_b64_tr_b16 v[136:137], v12 offset:4096
    ds_read_b64_tr_b16 v[138:139], v12 offset:4608
    ds_read_b64_tr_b16 v[140:141], v12 offset:5120
    ds_read_b64_tr_b16 v[142:143], v12 offset:5632
    s_bitcmp1_b32 s33, 26
    s_cbranch_scc1 F_B0_7
    v_pk_fma_f32 v[232:233], v[110:111], v[224:225], v[216:217]
    v_pk_fma_f32 v[234:235], v[126:127], v[226:227], v[218:219]
    v_pk_fma_f32 v[224:225], v[224:225], v[228:229], v[224:225]
    v_pk_fma_f32 v[226:227], v[226:227], v[230:231], v[226:227]
    v_pk_fma_f32 v[216:217], v[216:217], v[228:229], v[232:233]
    v_pk_fma_f32 v[218:219], v[218:219], v[230:231], v[234:235]
R_B0_7:
    s_lshr_b32 s33, vcc_lo, 4
    s_mov_b32 s32, vcc_lo
    s_or_b32 s33, s33, vcc_lo
    s_or_b32 s33, s33, s63
    s_sub_u32 s57, s57, 1
    s_cbranch_scc1 K2_LEND
    s_setprio 0
    v_mfma_f32_32x32x16_bf16 v[96:111], v[180:183], v[204:207], 0
    v_exp_f32 v228, v64
    v_exp_f32 v229, v65
    v_exp_f32 v230, v80
    v_exp_f32 v231, v81
    v_add_u32 v22, v28, v13
    v_add_u32_e64 v23, v29, v13
    s_bitcmp1_b32 s35, 0
    s_cbranch_scc1 F_A1_0
    v_pk_fma_f32 v[232:233], v[64:65], v[220:221], v[212:213]
    v_pk_fma_f32 v[234:235], v[80:81], v[222:223], v[214:215]
    v_pk_fma_f32 v[220:221], v[220:221], v[228:229], v[220:221]
    v_pk_fma_f32 v[222:223], v[222:223], v[230:231], v[222:223]
    v_pk_fma_f32 v[212:213], v[212:213], v[228:229], v[232:233]
    v_pk_fma_f32 v[214:215], v[214:215], v[230:231], v[234:235]
R_A1_0:
    v_mfma_f32_32x32x16_bf16 v[112:127], v[180:183], v[208:211], 0
    v_exp_f32 v228, v66
    v_exp_f32 v229, v67
    v_exp_f32 v230, v82
    v_exp_f32 v231, v83
    ds_read_b64_tr_b16 v[168:169], v22 offset:0
    ds_read_b64_tr_b16 v[170:171], v23 offset:0
    ds_read_b64_tr_b16 v[172:173], v22 offset:64
    ds_read_b64_tr_b16 v[174:175], v23 offset:64
    s_bitcmp1_b32 s35, 2
    s_cbranch_scc1 F_A1_1
    v_pk_fma_f32 v[232:233], v[66:67], v[220:221], v[212:213]
    v_pk_fma_f32 v[234:235], v[82:83], v[222:223], v[214:215]
    v_pk_fma_f32 v[220:221], v[220:221], v[228:229], v[220:221]
    v_pk_fma_f32 v[222:223], v[222:223], v[230:231], v[222:223]
    v_pk_fma_f32 v[212:213], v[212:213], v[228:229], v[232:233]
    v_pk_fma_f32 v[214:215], v[214:215], v[230:231], v[234:235]
R_A1_1:
    v_mfma_f32_32x32x16_bf16 v[96:111], v[184:187], v[160:163], v[96:111]
    v_exp_f32 v228, v68
    v_exp_f32 v229, v69
    v_exp_f32 v230, v84
    v_exp_f32 v231, v85
    s_mov_b32 m0, s58
    s_waitcnt lgkmcnt(4)
    buffer_load_dwordx4 v144, s[24:27], 0 offen offset:128  lds
    buffer_load_dwordx4 v145, s[24:27], 0 offen offset:1152  lds
    s_bitcmp1_b32 s35, 8
    s_cbranch_scc1 F_A1_2
    v_pk_fma_f32 v[232:233], v[68:69], v[220:221], v[212:213]
    v_pk_fma_f32 v[234:235], v[84:85], v[222:223], v[214:215]
    v_pk_fma_f32 v[220:221], v[220:221], v[228:229], v[220:221]
    v_pk_fma_f32 v[222:223], v[222:223], v[230:231], v[222:223]
    v_pk_fma_f32 v[212:213], v[212:213], v[228:229], v[232:233]
    v_pk_fma_f32 v[214:215], v[214:215], v[230:231], v[234:235]
R_A1_2:
    v_mfma_f32_32x32x16_bf16 v[112:127], v[184:187], v[164:167], v[112:127]
    v_exp_f32 v228, v70
    v_exp_f32 v229, v71
    v_exp_f32 v230, v86
    v_exp_f32 v231, v87
    buffer_load_dwordx4 v146, s[24:27], 0 offen offset:2176  lds
    buffer_load_dwordx4 v147, s[24:27], 0 offen offset:3200  lds
    s_bitcmp1_b32 s35, 10
    s_cbranch_scc1 F_A1_3
    v_pk_fma_f32 v[232:233], v[70:71], v[220:221], v[212:213]
    v_pk_fma_f32 v[234:235], v[86:87], v[222:223], v[214:215]
    v_pk_fma_f32 v[220:221], v[220:221], v[228:229], v[220:221]
    v_pk_fma_f32 v[222:223], v[222:223], v[230:231], v[222:223]
    v_pk_fma_f32 v[212:213], v[212:213], v[228:229], v[232:233]
    v_pk_fma_f32 v[214:215], v[214:215], v[230:231], v[234:235]
R_A1_3:
    v_smfmac_f32_32x32x32_bf16 v[96:111], v[188:191], v[128:135], v192
    v_exp_f32 v228, v72
    v_exp_f32 v229, v73
    v_exp_f32 v230, v88
    v_exp_f32 v231, v89
    ds_read_b128 v[184:187], v21
    s_cmp_lt_u32 s57, 2
    s_cbranch_scc1 WU2_1
WU2R_1:
    s_bitcmp1_b32 s35, 16
    s_cbranch_scc1 F_A1_4
    v_pk_fma_f32 v[232:233], v[72:73], v[220:221], v[212:213]
    v_pk_fma_f32 v[234:235], v[88:89], v[222:223], v[214:215]
    v_pk_fma_f32 v[220:221], v[220:221], v[228:229], v[220:221]
    v_pk_fma_f32 v[222:223], v[222:223], v[230:231], v[222:223]
    v_pk_fma_f32 v[212:213], v[212:213], v[228:229], v[232:233]
    v_pk_fma_f32 v[214:215], v[214:215], v[230:231], v[234:235]
R_A1_4:
    v_smfmac_f32_32x32x32_bf16 v[112:127], v[188:191], v[136:143], v192
    v_exp_f32 v228, v74
    v_exp_f32 v229, v75
    v_exp_f32 v230, v90
    v_exp_f32 v231, v91
    s_bitcmp1_b32 s35, 18
    s_cbranch_scc1 F_A1_5
    v_pk_fma_f32 v[232:233], v[74:75], v[220:221], v[212:213]
    v_pk_fma_f32 v[234:235], v[90:91], v[222:223], v[214:215]
    v_pk_fma_f32 v[220:221], v[220:221], v[228:229], v[220:221]
    v_pk_fma_f32 v[222:223], v[222:223], v[230:231], v[222:223]
    v_pk_fma_f32 v[212:213], v[212:213], v[228:229], v[232:233]
    v_pk_fma_f32 v[214:215], v[214:215], v[230:231], v[234:235]
R_A1_5:
    v_exp_f32 v228, v76
    v_exp_f32 v229, v77
    v_exp_f32 v230, v92
    v_exp_f32 v231, v93
    s_bitcmp1_b32 s35, 24
    s_cbranch_scc1 F_A1_6
    v_pk_fma_f32 v[232:233], v[76:77], v[220:221], v[212:213]
    v_pk_fma_f32 v[234:235], v[92:93], v[222:223], v[214:215]
    v_pk_fma_f32 v[220:221], v[220:221], v[228:229], v[220:221]
    v_pk_fma_f32 v[222:223], v[222:223], v[230:231], v[222:223]
    v_pk_fma_f32 v[212:213], v[212:213], v[228:229], v[232:233]
    v_pk_fma_f32 v[214:215], v[214:215], v[230:231], v[234:235]
R_A1_6:
    v_exp_f32 v228, v78
    v_exp_f32 v229, v79
    v_exp_f32_e64 v230, v94
    v_exp_f32 v231, v95
    s_waitcnt vmcnt(4) lgkmcnt(0)
    ds_read_b64_tr_b16 v[128:129], v11 offset:0
    ds_read_b64_tr_b16 v[130:131], v11 offset:512
    ds_read_b64_tr_b16 v[132:133], v11 offset:1024
    ds_read_b64_tr_b16 v[134:135], v11 offset:1536
    ds_read_b64_tr_b16 v[136:137], v12 offset:0
    ds_read_b64_tr_b16 v[138:139], v12 offset:512
    ds_read_b64_tr_b16 v[140:141], v12 offset:1024
    ds_read_b64_tr_b16 v[142:143], v12 offset:1536
    s_bitcmp1_b32 s35, 26
    s_cbranch_scc1 F_A1_7
    v_pk_fma_f32 v[232:233], v[78:79], v[220:221], v[212:213]
    v_pk_fma_f32 v[234:235], v[94:95], v[222:223], v[214:215]
    v_pk_fma_f32 v[220:221], v[220:221], v[228:229], v[220:221]
    v_pk_fma_f32 v[222:223], v[222:223], v[230:231], v[222:223]
    v_pk_fma_f32 v[212:213], v[212:213], v[228:229], v[232:233]
    v_pk_fma_f32 v[214:215], v[214:215], v[230:231], v[234:235]
R_A1_7:
    v_mfma_f32_32x32x16_bf16 v[64:79], v[176:179], v[196:199], 0
    v_exp_f32 v228, v96
    v_exp_f32 v229, v97
    v_exp_f32 v230, v112
    v_exp_f32 v231, v113
    ds_read_b64_tr_b16 v[160:161], v22 offset:128
    ds_read_b64_tr_b16 v[162:163], v23 offset:128
    ds_read_b64_tr_b16 v[164:165], v22 offset:192
    ds_read_b64_tr_b16 v[166:167], v23 offset:192
    s_bitcmp1_b32 s35, 0
    s_cbranch_scc1 F_B1_0
    v_pk_fma_f32 v[232:233], v[96:97], v[224:225], v[216:217]
    v_pk_fma_f32 v[234:235], v[112:113], v[226:227], v[218:219]
    v_pk_fma_f32 v[224:225], v[224:225], v[228:229], v[224:225]
    v_pk_fma_f32 v[226:227], v[226:227], v[230:231], v[226:227]
    v_pk_fma_f32 v[216:217], v[216:217], v[228:229], v[232:233]
    v_pk_fma_f32 v[218:219], v[218:219], v[230:231], v[234:235]
R_B1_0:
    v_mfma_f32_32x32x16_bf16 v[80:95], v[176:179], v[200:203], 0
    v_exp_f32 v228, v98
    v_exp_f32 v229, v99
    v_exp_f32 v230, v114
    v_exp_f32 v231, v115
    v_mad_u32_u16 v144, v148, s79, v152
    v_mad_u32_u16 v145, v149, s79, v153
    v_mad_u32_u16 v146, v150, s79, v154
    v_mad_u32_u16 v147, v151, s79, v155
    v_and_or_b32 v20, v30, s66, v16
    v_and_or_b32 v21, v30, 16, v14
    v_cmp_gt_i32_e64 vcc, 0, v30
    s_bitcmp1_b32 s35, 2
    s_cbranch_scc1 F_B1_1
    v_pk_fma_f32 v[232:233], v[98:99], v[224:225], v[216:217]
    v_pk_fma_f32 v[234:235], v[114:115], v[226:227], v[218:219]
    v_pk_fma_f32 v[224:225], v[224:225], v[228:229], v[224:225]
    v_pk_fma_f32 v[226:227], v[226:227], v[230:231], v[226:227]
    v_pk_fma_f32 v[216:217], v[216:217], v[228:229], v[232:233]
    v_pk_fma_f32 v[218:219], v[218:219], v[230:231], v[234:235]
R_B1_1:
    v_mfma_f32_32x32x16_bf16 v[64:79], v[184:187], v[168:171], v[64:79]
    v_exp_f32 v228, v100
    v_exp_f32 v229, v101
    v_exp_f32 v230, v116
    v_exp_f32 v231, v117
    s_mov_b32 m0, s59
    s_waitcnt lgkmcnt(4)
    buffer_load_dwordx4 v144, s[24:27], 0 offen  lds
    buffer_load_dwordx4 v145, s[24:27], 0 offen offset:1024  lds
    s_bitcmp1_b32 s35, 8
    s_cbranch_scc1 F_B1_2
    v_pk_fma_f32 v[232:233], v[100:101], v[224:225], v[216:217]
    v_pk_fma_f32 v[234:235], v[116:117], v[226:227], v[218:219]
    v_pk_fma_f32 v[224:225], v[224:225], v[228:229], v[224:225]
    v_pk_fma_f32 v[226:227], v[226:227], v[230:231], v[226:227]
    v_pk_fma_f32 v[216:217], v[216:217], v[228:229], v[232:233]
    v_pk_fma_f32 v[218:219], v[218:219], v[230:231], v[234:235]
R_B1_2:
    v_mfma_f32_32x32x16_bf16 v[80:95], v[184:187], v[172:175], v[80:95]
    v_exp_f32 v228, v102
    v_exp_f32 v229, v103
    v_exp_f32 v230, v118
    v_exp_f32 v231, v119
    buffer_load_dwordx4 v146, s[24:27], 0 offen offset:2048  lds
    buffer_load_dwordx4 v147, s[24:27], 0 offen offset:3072  lds
    buffer_load_dwordx4 v[180:183], v20, s[28:31], 0 offen
    s_bitcmp1_b32 s35, 10
    s_cbranch_scc1 F_B1_3
    v_pk_fma_f32 v[232:233], v[102:103], v[224:225], v[216:217]
    v_pk_fma_f32 v[234:235], v[118:119], v[226:227], v[218:219]
    v_pk_fma_f32 v[224:225], v[224:225], v[228:229], v[224:225]
    v_pk_fma_f32 v[226:227], v[226:227], v[230:231], v[226:227]
    v_pk_fma_f32 v[216:217], v[216:217], v[228:229], v[232:233]
    v_pk_fma_f32 v[218:219], v[218:219], v[230:231], v[234:235]
R_B1_3:
    v_smfmac_f32_32x32x32_bf16 v[64:79], v[188:191], v[128:135], v192
    v_exp_f32 v228, v104
    v_exp_f32 v229, v105
    v_exp_f32 v230, v120
    v_exp_f32 v231, v121
    ds_read_b32 v30, v7 offset:512
    ds_read2_b32 v[148:149], v8 offset0:128 offset1:136
    ds_read2_b32 v[150:151], v8 offset0:144 offset1:152
    ds_read_u16 v28, v9 offset:384
    ds_read_u16 v29, v9 offset:448
    s_bitcmp1_b32 s35, 16
    s_cbranch_scc1 F_B1_4
    v_pk_fma_f32 v[232:233], v[104:105], v[224:225], v[216:217]
    v_pk_fma_f32 v[234:235], v[120:121], v[226:227], v[218:219]
    v_pk_fma_f32 v[224:225], v[224:225], v[228:229], v[224:225]
    v_pk_fma_f32 v[226:227], v[226:227], v[230:231], v[226:227]
    v_pk_fma_f32 v[216:217], v[216:217], v[228:229], v[232:233]
    v_pk_fma_f32 v[218:219], v[218:219], v[230:231], v[234:235]
R_B1_4:
    v_smfmac_f32_32x32x32_bf16 v[80:95], v[188:191], v[136:143], v192
    v_exp_f32 v228, v106
    v_exp_f32 v229, v107
    v_exp_f32 v230, v122
    v_exp_f32 v231, v123
    v_add_u32 v7, s79, v7
    v_add_u32 v8, s79, v8
    v_add_u32_e64 v9, s79, v9
    s_bitcmp1_b32 s35, 18
    s_cbranch_scc1 F_B1_5
    v_pk_fma_f32 v[232:233], v[106:107], v[224:225], v[216:217]
    v_pk_fma_f32 v[234:235], v[122:123], v[226:227], v[218:219]
    v_pk_fma_f32 v[224:225], v[224:225], v[228:229], v[224:225]
    v_pk_fma_f32 v[226:227], v[226:227], v[230:231], v[226:227]
    v_pk_fma_f32 v[216:217], v[216:217], v[228:229], v[232:233]
    v_pk_fma_f32 v[218:219], v[218:219], v[230:231], v[234:235]
R_B1_5:
    v_exp_f32 v228, v108
    v_exp_f32 v229, v109
    v_exp_f32 v230, v124
    v_exp_f32 v231, v125
    s_bitcmp1_b32 s35, 24
    s_cbranch_scc1 F_B1_6
    v_pk_fma_f32 v[232:233], v[108:109], v[224:225], v[216:217]
    v_pk_fma_f32 v[234:235], v[124:125], v[226:227], v[218:219]
    v_pk_fma_f32 v[224:225], v[224:225], v[228:229], v[224:225]
    v_pk_fma_f32 v[226:227], v[226:227], v[230:231], v[226:227]
    v_pk_fma_f32 v[216:217], v[216:217], v[228:229], v[232:233]
    v_pk_fma_f32 v[218:219], v[218:219], v[230:231], v[234:235]
R_B1_6:
    v_exp_f32 v228, v110
    v_exp_f32 v229, v111
    v_exp_f32_e64 v230, v126
    v_exp_f32 v231, v127
    s_waitcnt vmcnt(5) lgkmcnt(0)
    ds_read_b64_tr_b16 v[128:129], v11 offset:4096
    ds_read_b64_tr_b16 v[130:131], v11 offset:4608
    ds_read_b64_tr_b16 v[132:133], v11 offset:5120
    ds_read_b64_tr_b16 v[134:135], v11 offset:5632
    ds_read_b64_tr_b16 v[136:137], v12 offset:4096
    ds_read_b64_tr_b16 v[138:139], v12 offset:4608
    ds_read_b64_tr_b16 v[140:141], v12 offset:5120
    ds_read_b64_tr_b16 v[142:143], v12 offset:5632
    s_bitcmp1_b32 s35, 26
    s_cbranch_scc1 F_B1_7
    v_pk_fma_f32 v[232:233], v[110:111], v[224:225], v[216:217]
    v_pk_fma_f32 v[234:235], v[126:127], v[226:227], v[218:219]
    v_pk_fma_f32 v[224:225], v[224:225], v[228:229], v[224:225]
    v_pk_fma_f32 v[226:227], v[226:227], v[230:231], v[226:227]
    v_pk_fma_f32 v[216:217], v[216:217], v[228:229], v[232:233]
    v_pk_fma_f32 v[218:219], v[218:219], v[230:231], v[234:235]
R_B1_7:
    s_lshr_b32 s35, vcc_lo, 4
    s_mov_b32 s34, vcc_lo
    s_or_b32 s35, s35, vcc_lo
    s_or_b32 s35, s35, s63
    s_sub_u32 s57, s57, 1
    s_cbranch_scc0 K2_LOOP
K2_LEND:
    v_rcp_f32 v40, v220
    v_rcp_f32 v41, v221
    v_rcp_f32 v42, v222
    v_rcp_f32 v43, v223
    v_max3_f32 v34, v220, v221, v34
    v_max3_f32 v34, v222, v223, v34
    s_waitcnt lgkmcnt(0)
    v_fmac_f32 v156, v212, v40
    v_fmac_f32 v157, v214, v42
    v_fmac_f32 v156, v213, v41
    v_fmac_f32_e64 v157, v215, v43
    ds_write2_b32 v32, v156, v157 offset1:32
    v_rcp_f32 v48, v224
    v_rcp_f32 v49, v225
    v_rcp_f32 v50, v226
    v_rcp_f32 v51, v227
    v_max3_f32 v34, v224, v225, v34
    v_max3_f32 v34, v226, v227, v34
    v_fmac_f32 v158, v216, v48
    v_fmac_f32 v159, v218, v50
    v_fmac_f32 v158, v217, v49
    v_fmac_f32 v159, v219, v51
    ds_write2_b32 v33, v158, v159 offset0:64 offset1:96
K2_AFTER:
    s_mov_b32 s68, 0
    s_bitcmp0_b32 s69, 0
    s_cselect_b32 s82, -1, 0
    s_bitcmp0_b32 s69, 4
    s_cselect_b32 s83, -1, 0
    s_lshr_b32 s71, s22, 2
    s_lshl_b32 s72, s71, 5
    v_add_u32 v48, s72, v2
    v_mul_u32_u24 v49, 528, v48
    v_cmp_gt_u32 s[80:81], 49, v48
    s_and_b32 s72, s22, 3
    s_lshl_b32 s72, s72, 7
    v_lshl_add_u32 v45, v16, 1, s72
    v_add_u32_e64 v46, v49, v45
    v_add_u32 v44, 65536, v36
    s_add_u32 s72, s65, 4352
    v_lshl_add_u32 v42, v1, 4, s72
    s_lshl_b32 s71, s71, 15
    s_add_u32 s71, s71, 102400
    v_lshl_add_u32 v43, v1, 4, s71
    s_or_b32 s70, s88, s89
    s_or_b32 s70, s70, s67
    s_cbranch_scc1 K2_SLOWM
    s_and_b32 exec_lo, s82, 1
    s_and_b32 exec_hi, s83, 1
    ds_write_b32 v17, v31 offset:512
K2_MERGED:
    s_mov_b64 exec, s[80:81]
    s_waitcnt vmcnt(0) lgkmcnt(0)
    s_barrier
    s_cmp_lg_u32 s67, 0
    s_cbranch_scc1 K2_MORE
    ds_read_b32 v47, v49 offset:31312
    ds_read_b128 v[64:67], v46 offset:30800
    ds_read_b128 v[68:71], v46 offset:30816
    ds_read_b128 v[72:75], v46 offset:30864
    ds_read_b128 v[76:79], v46 offset:30880
    s_waitcnt lgkmcnt(4)
    v_cmpx_ne_u32 vcc, 0, v47
    v_add_u32 v47, v47, v45
    ds_read_b128 v[80:83], v47 offset:0
    ds_read_b128 v[84:87], v47 offset:16
    ds_read_b128 v[88:91], v47 offset:64
    ds_read_b128 v[92:95], v47 offset:80
    s_mov_b64 exec, -1
    ds_read_b64_tr_b16 v[128:129], v44 offset:0
    ds_read_b64_tr_b16 v[130:131], v44 offset:1024
    ds_read_b64_tr_b16 v[132:133], v44 offset:4096
    ds_read_b64_tr_b16 v[134:135], v44 offset:5120
    ds_read_b64_tr_b16 v[136:137], v44 offset:8192
    ds_read_b64_tr_b16 v[138:139], v44 offset:9216
    ds_read_b64_tr_b16 v[140:141], v44 offset:12288
    ds_read_b64_tr_b16 v[142:143], v44 offset:13312
    s_mov_b64 exec, vcc
    s_waitcnt lgkmcnt(11)
    v_pk_add_f32 v[64:65], v[64:65], v[80:81]
    v_pk_add_f32 v[66:67], v[66:67], v[82:83]
    s_waitcnt lgkmcnt(10)
    v_pk_add_f32 v[68:69], v[68:69], v[84:85]
    v_pk_add_f32 v[70:71], v[70:71], v[86:87]
    s_waitcnt lgkmcnt(9)
    v_pk_add_f32 v[72:73], v[72:73], v[88:89]
    v_pk_add_f32 v[74:75], v[74:75], v[90:91]
    s_waitcnt lgkmcnt(8)
    v_pk_add_f32 v[76:77], v[76:77], v[92:93]
    v_pk_add_f32 v[78:79], v[78:79], v[94:95]
    s_mov_b64 exec, -1
    v_cvt_pk_bf16_f32 v96, v64, v65
    v_cvt_pk_bf16_f32 v97, v66, v67
    v_cvt_pk_bf16_f32 v98, v68, v69
    v_cvt_pk_bf16_f32 v99, v70, v71
    ds_write_b128 v42, v[96:99] offset:0
    v_cvt_pk_bf16_f32 v100, v72, v73
    v_cvt_pk_bf16_f32 v101, v74, v75
    v_cvt_pk_bf16_f32 v102, v76, v77
    v_cvt_pk_bf16_f32 v103, v78, v79
    ds_write_b128 v42, v[100:103] offset:1024
    ds_read_b64_tr_b16 v[144:145], v44 offset:16384
    ds_read_b64_tr_b16 v[146:147], v44 offset:17408
    ds_read_b64_tr_b16 v[148:149], v44 offset:20480
    ds_read_b64_tr_b16 v[150:151], v44 offset:21504
    ds_read_b64_tr_b16 v[152:153], v44 offset:24576
    ds_read_b64_tr_b16 v[154:155], v44 offset:25600
    ds_read_b64_tr_b16 v[156:157], v44 offset:28672
    ds_read_b64_tr_b16 v[158:159], v44 offset:29696
    s_waitcnt lgkmcnt(8)
    s_barrier
    ds_read_b128 v[64:67], v43 offset:0
    ds_read_b128 v[68:71], v43 offset:1024
    ds_read_b128 v[72:75], v43 offset:8192
    ds_read_b128 v[76:79], v43 offset:9216
    ds_read_b128 v[80:83], v43 offset:16384
    ds_read_b128 v[84:87], v43 offset:17408
    ds_read_b128 v[88:91], v43 offset:24576
    ds_read_b128 v[92:95], v43 offset:25600
    v_mul_u32_u24 v50, 80, v2
    v_lshl_add_u32 v50, v16, 1, v50
    s_add_u32 s71, s65, 256
    v_add_u32 v50, s71, v50
    v_lshrrev_b32 v52, 2, v1
    v_and_b32 v54, 3, v1
    v_lshlrev_b32_e64 v54, 4, v54
    v_lshl_add_u32 v53, v52, 8, v54
    v_mul_u32_u24 v52, 80, v52
    v_add3_u32 v52, v52, v54, s71
    s_lshr_b32 s73, s22, 2
    s_lshl_b32 s73, s73, 13
    s_and_b32 s74, s22, 3
    s_lshl_b32 s74, s74, 6
    s_add_u32 s73, s73, s74
    v_add_u32_e64 v53, s73, v53
    s_waitcnt lgkmcnt(7)
    v_mfma_f32_32x32x16_bf16 v[160:175], v[128:131], v[64:67], v[236:251]
    s_waitcnt lgkmcnt(6)
    v_mfma_f32_32x32x16_bf16 v[160:175], v[132:135], v[68:71], v[160:175]
    s_waitcnt lgkmcnt(5)
    v_mfma_f32_32x32x16_bf16 v[160:175], v[136:139], v[72:75], v[160:175]
    s_waitcnt lgkmcnt(4)
    v_mfma_f32_32x32x16_bf16 v[160:175], v[140:143], v[76:79], v[160:175]
    s_waitcnt lgkmcnt(3)
    v_mfma_f32_32x32x16_bf16 v[160:175], v[144:147], v[80:83], v[160:175]
    s_waitcnt lgkmcnt(2)
    v_mfma_f32_32x32x16_bf16 v[160:175], v[148:151], v[84:87], v[160:175]
    s_waitcnt lgkmcnt(1)
    v_mfma_f32_32x32x16_bf16 v[160:175], v[152:155], v[88:91], v[160:175]
    s_waitcnt lgkmcnt(0)
    v_mfma_f32_32x32x16_bf16 v[160:175], v[156:159], v[92:95], v[160:175]
    s_mov_b32 s71, 0xbfb8aa3b
    s_mov_b32 s70, 0xbfb8aa3b
    s_mov_b32 s72, 0x7b800000
    v_cmp_le_f32 s[82:83], s72, v34
    v_mov_b32 v51, 0x207
    s_nop 6
    v_cmp_class_f32 vcc, v160, v51
    v_exp_f32 v64, v160
    v_exp_f32 v65, v161
    v_exp_f32 v66, v162
    v_exp_f32 v67, v163
    v_exp_f32 v68, v164
    v_exp_f32 v69, v165
    v_exp_f32 v70, v166
    v_exp_f32_e64 v71, v167
    s_and_b64 vcc, vcc, s[80:81]
    s_or_b64 s[82:83], vcc, s[82:83]
    v_pk_fma_f32 v[64:65], v[64:65], s[70:71], s[70:71]
    v_pk_fma_f32 v[66:67], v[66:67], s[70:71], s[70:71]
    v_pk_fma_f32 v[68:69], v[68:69], s[70:71], s[70:71]
    v_pk_fma_f32 v[70:71], v[70:71], s[70:71], s[70:71]
    v_rcp_f32 v64, v64
    v_rcp_f32 v65, v65
    v_rcp_f32 v66, v66
    v_rcp_f32 v67, v67
    v_rcp_f32 v68, v68
    v_rcp_f32 v69, v69
    v_rcp_f32 v70, v70
    v_rcp_f32 v71, v71
    v_pk_mul_f32 v[64:65], v[160:161], v[64:65]
    v_pk_mul_f32 v[66:67], v[162:163], v[66:67]
    v_pk_mul_f32 v[68:69], v[164:165], v[68:69]
    v_pk_mul_f32 v[70:71], v[166:167], v[70:71]
    v_cvt_pk_bf16_f32 v80, v64, v65
    v_cvt_pk_bf16_f32 v81, v66, v67
    v_cvt_pk_bf16_f32 v82, v68, v69
    v_cvt_pk_bf16_f32 v83, v70, v71
    ds_write_b128 v50, v[80:83]
    v_exp_f32 v72, v168
    v_exp_f32 v73, v169
    v_exp_f32 v74, v170
    v_exp_f32 v75, v171
    v_exp_f32 v76, v172
    v_exp_f32 v77, v173
    v_exp_f32_e64 v78, v174
    v_exp_f32 v79, v175
    s_nop 0
    v_pk_fma_f32 v[72:73], v[72:73], s[70:71], s[70:71]
    v_pk_fma_f32 v[74:75], v[74:75], s[70:71], s[70:71]
    v_pk_fma_f32 v[76:77], v[76:77], s[70:71], s[70:71]
    v_pk_fma_f32 v[78:79], v[78:79], s[70:71], s[70:71]
    v_rcp_f32 v72, v72
    v_rcp_f32 v73, v73
    v_rcp_f32 v74, v74
    v_rcp_f32 v75, v75
    v_rcp_f32 v76, v76
    v_rcp_f32 v77, v77
    v_rcp_f32 v78, v78
    v_rcp_f32 v79, v79
    v_pk_mul_f32 v[72:73], v[168:169], v[72:73]
    v_pk_mul_f32 v[74:75], v[170:171], v[74:75]
    v_pk_mul_f32 v[76:77], v[172:173], v[76:77]
    v_pk_mul_f32 v[78:79], v[174:175], v[78:79]
    v_cvt_pk_bf16_f32 v84, v72, v73
    v_cvt_pk_bf16_f32 v85, v74, v75
    v_cvt_pk_bf16_f32 v86, v76, v77
    v_cvt_pk_bf16_f32 v87, v78, v79
    ds_write_b128 v50, v[84:87] offset:16
    ds_read_b128 v[88:91], v52
    ds_read_b128 v[92:95], v52 offset:1280
    v_mov_b32_e64 v40, 1
    v_mov_b32 v41, 260
    s_movk_i32 s71, 4096
    s_waitcnt lgkmcnt(1)
    buffer_store_dwordx4 v[88:91], v53, s[36:39], 0 offen sc1
    s_waitcnt lgkmcnt(0)
    buffer_store_dwordx4 v[92:95], v53, s[36:39], s71 offen sc1
    s_mov_b64 exec, s[82:83]
    ds_write_b32 v41, v40
    s_mov_b64 exec, -1
    s_waitcnt lgkmcnt(0)
    s_barrier
    ds_read_b32 v40, v41
    s_waitcnt lgkmcnt(0)
    v_readfirstlane_b32 s70, v40
    s_cmp_lg_u32 s63, 0
    s_cbranch_scc1 K2_END
    s_cmp_lg_u32 s70, 0
    s_cbranch_scc1 K2_SAFE
K2_END:
    s_endpgm
F_A0_0:
    v_rcp_f32 v40, v220
    s_bitcmp1_b32 s32, 0
    v_rcp_f32 v41, v221
    s_cselect_b32 s70, -1, 0
    v_rcp_f32 v42, v222
    s_bitcmp1_b32 s32, 4
    v_rcp_f32 v43, v223
    s_cselect_b32 s71, -1, 0
    v_max3_f32 v34, v220, v221, v34
    v_max3_f32 v34, v222, v223, v34
    v_mov_b32_dpp v46, v22 row_newbcast:0 row_mask:0xf bank_mask:0xf
    s_waitcnt lgkmcnt(0)
    v_fmac_f32 v156, v212, v40
    v_fmac_f32 v157, v214, v42
    v_fmac_f32 v156, v213, v41
    v_fmac_f32 v157, v215, v43
    s_mov_b64 exec, s[70:71]
    ds_write2_b32 v32, v156, v157 offset0:0 offset1:32
    v_lshl_add_u32 v32, v46, 1, v15
    ds_read2_b32 v[156:157], v32 offset0:0 offset1:32
    s_mov_b64 exec, -1
    v_pk_add_f32 v[220:221], v[228:229], 1.0 op_sel_hi:[1,0]
    v_pk_add_f32 v[222:223], v[230:231], 1.0 op_sel_hi:[1,0]
    v_pk_mov_b32 v[212:213], v[64:65], v[64:65] op_sel:[0,1]
    v_pk_mov_b32 v[214:215], v[80:81], v[80:81] op_sel:[0,1]
    s_branch R_A0_0
F_A0_1:
    v_rcp_f32 v40, v220
    s_bitcmp1_b32 s32, 3
    s_cbranch_scc1 EXA0_1
    v_rcp_f32 v41, v221
    s_bitcmp1_b32 s32, 2
    s_cselect_b32 s70, -1, 0
    v_rcp_f32 v42, v222
    s_bitcmp1_b32 s32, 6
    v_rcp_f32 v43, v223
    s_cselect_b32 s71, -1, 0
    v_max3_f32 v34, v220, v221, v34
    v_max3_f32 v34, v222, v223, v34
    v_mov_b32_dpp v46, v22 row_newbcast:4 row_mask:0xf bank_mask:0xf
    s_waitcnt lgkmcnt(0)
    v_fmac_f32 v156, v212, v40
    v_fmac_f32 v157, v214, v42
    v_fmac_f32 v156, v213, v41
    v_fmac_f32 v157, v215, v43
    s_mov_b64 exec, s[70:71]
    ds_write2_b32 v32, v156, v157 offset0:0 offset1:32
    v_lshl_add_u32 v32, v46, 1, v15
    ds_read2_b32 v[156:157], v32 offset0:0 offset1:32
    s_mov_b64 exec, -1
    v_pk_add_f32 v[220:221], v[228:229], 1.0 op_sel_hi:[1,0]
    v_pk_add_f32 v[222:223], v[230:231], 1.0 op_sel_hi:[1,0]
    v_pk_mov_b32 v[212:213], v[66:67], v[66:67] op_sel:[0,1]
    v_pk_mov_b32 v[214:215], v[82:83], v[82:83] op_sel:[0,1]
    s_branch R_A0_1
F_A0_2:
    v_rcp_f32 v40, v220
    s_bitcmp1_b32 s32, 9
    s_cbranch_scc1 EXA0_2
    v_rcp_f32 v41, v221
    s_bitcmp1_b32 s32, 8
    s_cselect_b32 s70, -1, 0
    v_rcp_f32 v42, v222
    s_bitcmp1_b32 s32, 12
    v_rcp_f32 v43, v223
    s_cselect_b32 s71, -1, 0
    v_max3_f32 v34, v220, v221, v34
    v_max3_f32 v34, v222, v223, v34
    v_mov_b32_dpp v46, v22 row_newbcast:8 row_mask:0xf bank_mask:0xf
    s_waitcnt lgkmcnt(0)
    v_fmac_f32 v156, v212, v40
    v_fmac_f32 v157, v214, v42
    v_fmac_f32 v156, v213, v41
    v_fmac_f32 v157, v215, v43
    s_mov_b64 exec, s[70:71]
    ds_write2_b32 v32, v156, v157 offset0:0 offset1:32
    v_lshl_add_u32 v32, v46, 1, v15
    ds_read2_b32 v[156:157], v32 offset0:0 offset1:32
    s_mov_b64 exec, -1
    v_pk_add_f32 v[220:221], v[228:229], 1.0 op_sel_hi:[1,0]
    v_pk_add_f32 v[222:223], v[230:231], 1.0 op_sel_hi:[1,0]
    v_pk_mov_b32 v[212:213], v[68:69], v[68:69] op_sel:[0,1]
    v_pk_mov_b32 v[214:215], v[84:85], v[84:85] op_sel:[0,1]
    s_branch R_A0_2
F_A0_3:
    v_rcp_f32 v40, v220
    s_bitcmp1_b32 s32, 11
    s_cbranch_scc1 EXA0_3
    v_rcp_f32 v41, v221
    s_bitcmp1_b32 s32, 10
    s_cselect_b32 s70, -1, 0
    v_rcp_f32 v42, v222
    s_bitcmp1_b32 s32, 14
    v_rcp_f32 v43, v223
    s_cselect_b32 s71, -1, 0
    v_max3_f32 v34, v220, v221, v34
    v_max3_f32 v34, v222, v223, v34
    v_mov_b32_dpp v46, v22 row_newbcast:12 row_mask:0xf bank_mask:0xf
    s_waitcnt lgkmcnt(0)
    v_fmac_f32 v156, v212, v40
    v_fmac_f32 v157, v214, v42
    v_fmac_f32 v156, v213, v41
    v_fmac_f32 v157, v215, v43
    s_mov_b64 exec, s[70:71]
    ds_write2_b32 v32, v156, v157 offset0:0 offset1:32
    v_lshl_add_u32 v32, v46, 1, v15
    ds_read2_b32 v[156:157], v32 offset0:0 offset1:32
    s_mov_b64 exec, -1
    v_pk_add_f32 v[220:221], v[228:229], 1.0 op_sel_hi:[1,0]
    v_pk_add_f32 v[222:223], v[230:231], 1.0 op_sel_hi:[1,0]
    v_pk_mov_b32 v[212:213], v[70:71], v[70:71] op_sel:[0,1]
    v_pk_mov_b32 v[214:215], v[86:87], v[86:87] op_sel:[0,1]
    s_branch R_A0_3
F_A0_4:
    v_rcp_f32 v40, v220
    s_bitcmp1_b32 s32, 17
    s_cbranch_scc1 EXA0_4
    v_rcp_f32 v41, v221
    s_bitcmp1_b32 s32, 16
    s_cselect_b32 s70, -1, 0
    v_rcp_f32 v42, v222
    s_bitcmp1_b32 s32, 20
    v_rcp_f32 v43, v223
    s_cselect_b32 s71, -1, 0
    v_max3_f32 v34, v220, v221, v34
    v_max3_f32 v34, v222, v223, v34
    v_mov_b32_dpp v46, v23 row_newbcast:0 row_mask:0xf bank_mask:0xf
    s_waitcnt lgkmcnt(0)
    v_fmac_f32 v156, v212, v40
    v_fmac_f32 v157, v214, v42
    v_fmac_f32 v156, v213, v41
    v_fmac_f32 v157, v215, v43
    s_mov_b64 exec, s[70:71]
    ds_write2_b32 v32, v156, v157 offset0:0 offset1:32
    v_lshl_add_u32 v32, v46, 1, v15
    ds_read2_b32 v[156:157], v32 offset0:0 offset1:32
    s_mov_b64 exec, -1
    v_pk_add_f32 v[220:221], v[228:229], 1.0 op_sel_hi:[1,0]
    v_pk_add_f32 v[222:223], v[230:231], 1.0 op_sel_hi:[1,0]
    v_pk_mov_b32 v[212:213], v[72:73], v[72:73] op_sel:[0,1]
    v_pk_mov_b32 v[214:215], v[88:89], v[88:89] op_sel:[0,1]
    s_branch R_A0_4
F_A0_5:
    v_rcp_f32 v40, v220
    s_bitcmp1_b32 s32, 19
    s_cbranch_scc1 EXA0_5
    v_rcp_f32 v41, v221
    s_bitcmp1_b32 s32, 18
    s_cselect_b32 s70, -1, 0
    v_rcp_f32 v42, v222
    s_bitcmp1_b32 s32, 22
    v_rcp_f32 v43, v223
    s_cselect_b32 s71, -1, 0
    v_max3_f32 v34, v220, v221, v34
    v_max3_f32 v34, v222, v223, v34
    v_mov_b32_dpp v46, v23 row_newbcast:4 row_mask:0xf bank_mask:0xf
    s_waitcnt lgkmcnt(0)
    v_fmac_f32 v156, v212, v40
    v_fmac_f32 v157, v214, v42
    v_fmac_f32 v156, v213, v41
    v_fmac_f32 v157, v215, v43
    s_mov_b64 exec, s[70:71]
    ds_write2_b32 v32, v156, v157 offset0:0 offset1:32
    v_lshl_add_u32 v32, v46, 1, v15
    ds_read2_b32 v[156:157], v32 offset0:0 offset1:32
    s_mov_b64 exec, -1
    v_pk_add_f32 v[220:221], v[228:229], 1.0 op_sel_hi:[1,0]
    v_pk_add_f32 v[222:223], v[230:231], 1.0 op_sel_hi:[1,0]
    v_pk_mov_b32 v[212:213], v[74:75], v[74:75] op_sel:[0,1]
    v_pk_mov_b32 v[214:215], v[90:91], v[90:91] op_sel:[0,1]
    s_branch R_A0_5
F_A0_6:
    v_rcp_f32 v40, v220
    s_bitcmp1_b32 s32, 25
    s_cbranch_scc1 R_A0_7
    v_rcp_f32 v41, v221
    s_bitcmp1_b32 s32, 24
    s_cselect_b32 s70, -1, 0
    v_rcp_f32 v42, v222
    s_bitcmp1_b32 s32, 28
    v_rcp_f32 v43, v223
    s_cselect_b32 s71, -1, 0
    v_max3_f32 v34, v220, v221, v34
    v_max3_f32 v34, v222, v223, v34
    v_mov_b32_dpp v46, v23 row_newbcast:8 row_mask:0xf bank_mask:0xf
    s_waitcnt lgkmcnt(0)
    v_fmac_f32 v156, v212, v40
    v_fmac_f32 v157, v214, v42
    v_fmac_f32 v156, v213, v41
    v_fmac_f32 v157, v215, v43
    s_mov_b64 exec, s[70:71]
    ds_write2_b32 v32, v156, v157 offset0:0 offset1:32
    v_lshl_add_u32 v32, v46, 1, v15
    ds_read2_b32 v[156:157], v32 offset0:0 offset1:32
    s_mov_b64 exec, -1
    v_pk_add_f32 v[220:221], v[228:229], 1.0 op_sel_hi:[1,0]
    v_pk_add_f32 v[222:223], v[230:231], 1.0 op_sel_hi:[1,0]
    v_pk_mov_b32 v[212:213], v[76:77], v[76:77] op_sel:[0,1]
    v_pk_mov_b32 v[214:215], v[92:93], v[92:93] op_sel:[0,1]
    s_branch R_A0_6
F_A0_7:
    v_rcp_f32 v40, v220
    s_bitcmp1_b32 s32, 27
    s_cbranch_scc1 R_A0_7
    v_rcp_f32 v41, v221
    s_bitcmp1_b32 s32, 26
    s_cselect_b32 s70, -1, 0
    v_rcp_f32 v42, v222
    s_bitcmp1_b32 s32, 30
    v_rcp_f32 v43, v223
    s_cselect_b32 s71, -1, 0
    v_max3_f32 v34, v220, v221, v34
    v_max3_f32 v34, v222, v223, v34
    v_mov_b32_dpp v46, v23 row_newbcast:12 row_mask:0xf bank_mask:0xf
    s_waitcnt lgkmcnt(0)
    v_fmac_f32 v156, v212, v40
    v_fmac_f32 v157, v214, v42
    v_fmac_f32 v156, v213, v41
    v_fmac_f32 v157, v215, v43
    s_mov_b64 exec, s[70:71]
    ds_write2_b32 v32, v156, v157 offset0:0 offset1:32
    v_lshl_add_u32 v32, v46, 1, v15
    ds_read2_b32 v[156:157], v32 offset0:0 offset1:32
    s_mov_b64 exec, -1
    v_pk_add_f32 v[220:221], v[228:229], 1.0 op_sel_hi:[1,0]
    v_pk_add_f32 v[222:223], v[230:231], 1.0 op_sel_hi:[1,0]
    v_pk_mov_b32 v[212:213], v[78:79], v[78:79] op_sel:[0,1]
    v_pk_mov_b32 v[214:215], v[94:95], v[94:95] op_sel:[0,1]
    s_branch R_A0_7
WU2_0:
    s_mov_b32 s26, 0
    s_mov_b32 s30, 0
    s_or_b64 s[34:35], s[34:35], s[52:53]
    s_cmp_lg_u32 s57, 0
    s_cbranch_scc1 WU2R_0
    s_add_u32 s70, s64, 32768
    s_add_u32 m0, s64, 65536
    s_nop 0
    buffer_load_dwordx4 v35, s[48:51], s70 offen lds
    buffer_load_dwordx4 v35, s[48:51], s70 offen offset:1024 lds
    buffer_load_dwordx4 v35, s[48:51], s70 offen offset:2048 lds
    buffer_load_dwordx4 v35, s[48:51], s70 offen offset:3072 lds
    s_branch WU2R_0
    s_nop 0
EXA0_1:
    s_waitcnt lgkmcnt(0)
    v_mfma_f32_32x32x16_bf16 v[96:111], v[184:187], v[160:163], v[96:111]
EXA0_2:
    v_mfma_f32_32x32x16_bf16 v[112:127], v[184:187], v[164:167], v[112:127]
EXA0_3:
    v_smfmac_f32_32x32x32_bf16 v[96:111], v[188:191], v[128:135], v192
    s_add_u32 s70, s64, 32768
    s_add_u32 m0, s64, 65536
    s_nop 0
    buffer_load_dwordx4 v35, s[48:51], s70 offen lds
    buffer_load_dwordx4 v35, s[48:51], s70 offen offset:1024 lds
    buffer_load_dwordx4 v35, s[48:51], s70 offen offset:2048 lds
    buffer_load_dwordx4 v35, s[48:51], s70 offen offset:3072 lds
EXA0_4:
    v_smfmac_f32_32x32x32_bf16 v[112:127], v[188:191], v[136:143], v192
    s_nop 7
EXA0_5:
    s_branch R_A0_7
F_B0_0:
    v_rcp_f32 v48, v224
    s_bitcmp1_b32 s32, 0
    v_rcp_f32 v49, v225
    s_cselect_b32 s70, -1, 0
    v_rcp_f32 v50, v226
    s_bitcmp1_b32 s32, 4
    v_rcp_f32 v51, v227
    s_cselect_b32 s71, -1, 0
    v_max3_f32 v34, v224, v225, v34
    v_max3_f32 v34, v226, v227, v34
    v_mov_b32_dpp v54, v22 row_newbcast:0 row_mask:0xf bank_mask:0xf
    s_waitcnt lgkmcnt(0)
    v_fmac_f32 v158, v216, v48
    v_fmac_f32 v159, v218, v50
    v_fmac_f32 v158, v217, v49
    v_fmac_f32 v159, v219, v51
    s_mov_b64 exec, s[70:71]
    ds_write2_b32 v33, v158, v159 offset0:64 offset1:96
    v_lshl_add_u32 v33, v54, 1, v15
    ds_read2_b32 v[158:159], v33 offset0:64 offset1:96
    s_mov_b64 exec, -1
    v_pk_add_f32 v[224:225], v[228:229], 1.0 op_sel_hi:[1,0]
    v_pk_add_f32 v[226:227], v[230:231], 1.0 op_sel_hi:[1,0]
    v_pk_mov_b32 v[216:217], v[96:97], v[96:97] op_sel:[0,1]
    v_pk_mov_b32 v[218:219], v[112:113], v[112:113] op_sel:[0,1]
    s_branch R_B0_0
F_B0_1:
    v_rcp_f32 v48, v224
    s_bitcmp1_b32 s32, 3
    s_cbranch_scc1 K2_LEND
    v_rcp_f32 v49, v225
    s_bitcmp1_b32 s32, 2
    s_cselect_b32 s70, -1, 0
    v_rcp_f32 v50, v226
    s_bitcmp1_b32 s32, 6
    v_rcp_f32 v51, v227
    s_cselect_b32 s71, -1, 0
    v_max3_f32 v34, v224, v225, v34
    v_max3_f32 v34, v226, v227, v34
    v_mov_b32_dpp v54, v22 row_newbcast:4 row_mask:0xf bank_mask:0xf
    s_waitcnt lgkmcnt(0)
    v_fmac_f32 v158, v216, v48
    v_fmac_f32 v159, v218, v50
    v_fmac_f32 v158, v217, v49
    v_fmac_f32 v159, v219, v51
    s_mov_b64 exec, s[70:71]
    ds_write2_b32 v33, v158, v159 offset0:64 offset1:96
    v_lshl_add_u32 v33, v54, 1, v15
    ds_read2_b32 v[158:159], v33 offset0:64 offset1:96
    s_mov_b64 exec, -1
    v_pk_add_f32 v[224:225], v[228:229], 1.0 op_sel_hi:[1,0]
    v_pk_add_f32 v[226:227], v[230:231], 1.0 op_sel_hi:[1,0]
    v_pk_mov_b32 v[216:217], v[98:99], v[98:99] op_sel:[0,1]
    v_pk_mov_b32 v[218:219], v[114:115], v[114:115] op_sel:[0,1]
    s_branch R_B0_1
F_B0_2:
    v_rcp_f32 v48, v224
    s_bitcmp1_b32 s32, 9
    s_cbranch_scc1 K2_LEND
    v_rcp_f32 v49, v225
    s_bitcmp1_b32 s32, 8
    s_cselect_b32 s70, -1, 0
    v_rcp_f32 v50, v226
    s_bitcmp1_b32 s32, 12
    v_rcp_f32 v51, v227
    s_cselect_b32 s71, -1, 0
    v_max3_f32 v34, v224, v225, v34
    v_max3_f32 v34, v226, v227, v34
    v_mov_b32_dpp v54, v22 row_newbcast:8 row_mask:0xf bank_mask:0xf
    s_waitcnt lgkmcnt(0)
    v_fmac_f32 v158, v216, v48
    v_fmac_f32 v159, v218, v50
    v_fmac_f32 v158, v217, v49
    v_fmac_f32 v159, v219, v51
    s_mov_b64 exec, s[70:71]
    ds_write2_b32 v33, v158, v159 offset0:64 offset1:96
    v_lshl_add_u32 v33, v54, 1, v15
    ds_read2_b32 v[158:159], v33 offset0:64 offset1:96
    s_mov_b64 exec, -1
    v_pk_add_f32 v[224:225], v[228:229], 1.0 op_sel_hi:[1,0]
    v_pk_add_f32 v[226:227], v[230:231], 1.0 op_sel_hi:[1,0]
    v_pk_mov_b32 v[216:217], v[100:101], v[100:101] op_sel:[0,1]
    v_pk_mov_b32 v[218:219], v[116:117], v[116:117] op_sel:[0,1]
    s_branch R_B0_2
F_B0_3:
    v_rcp_f32 v48, v224
    s_bitcmp1_b32 s32, 11
    s_cbranch_scc1 K2_LEND
    v_rcp_f32 v49, v225
    s_bitcmp1_b32 s32, 10
    s_cselect_b32 s70, -1, 0
    v_rcp_f32 v50, v226
    s_bitcmp1_b32 s32, 14
    v_rcp_f32 v51, v227
    s_cselect_b32 s71, -1, 0
    v_max3_f32 v34, v224, v225, v34
    v_max3_f32 v34, v226, v227, v34
    v_mov_b32_dpp v54, v22 row_newbcast:12 row_mask:0xf bank_mask:0xf
    s_waitcnt lgkmcnt(0)
    v_fmac_f32 v158, v216, v48
    v_fmac_f32 v159, v218, v50
    v_fmac_f32 v158, v217, v49
    v_fmac_f32 v159, v219, v51
    s_mov_b64 exec, s[70:71]
    ds_write2_b32 v33, v158, v159 offset0:64 offset1:96
    v_lshl_add_u32 v33, v54, 1, v15
    ds_read2_b32 v[158:159], v33 offset0:64 offset1:96
    s_mov_b64 exec, -1
    v_pk_add_f32 v[224:225], v[228:229], 1.0 op_sel_hi:[1,0]
    v_pk_add_f32 v[226:227], v[230:231], 1.0 op_sel_hi:[1,0]
    v_pk_mov_b32 v[216:217], v[102:103], v[102:103] op_sel:[0,1]
    v_pk_mov_b32 v[218:219], v[118:119], v[118:119] op_sel:[0,1]
    s_branch R_B0_3
F_B0_4:
    v_rcp_f32 v48, v224
    s_bitcmp1_b32 s32, 17
    s_cbranch_scc1 K2_LEND
    v_rcp_f32 v49, v225
    s_bitcmp1_b32 s32, 16
    s_cselect_b32 s70, -1, 0
    v_rcp_f32 v50, v226
    s_bitcmp1_b32 s32, 20
    v_rcp_f32 v51, v227
    s_cselect_b32 s71, -1, 0
    v_max3_f32 v34, v224, v225, v34
    v_max3_f32 v34, v226, v227, v34
    v_mov_b32_dpp v54, v23 row_newbcast:0 row_mask:0xf bank_mask:0xf
    s_waitcnt lgkmcnt(0)
    v_fmac_f32 v158, v216, v48
    v_fmac_f32 v159, v218, v50
    v_fmac_f32 v158, v217, v49
    v_fmac_f32 v159, v219, v51
    s_mov_b64 exec, s[70:71]
    ds_write2_b32 v33, v158, v159 offset0:64 offset1:96
    v_lshl_add_u32 v33, v54, 1, v15
    ds_read2_b32 v[158:159], v33 offset0:64 offset1:96
    s_mov_b64 exec, -1
    v_pk_add_f32 v[224:225], v[228:229], 1.0 op_sel_hi:[1,0]
    v_pk_add_f32 v[226:227], v[230:231], 1.0 op_sel_hi:[1,0]
    v_pk_mov_b32 v[216:217], v[104:105], v[104:105] op_sel:[0,1]
    v_pk_mov_b32 v[218:219], v[120:121], v[120:121] op_sel:[0,1]
    s_branch R_B0_4
F_B0_5:
    v_rcp_f32 v48, v224
    s_bitcmp1_b32 s32, 19
    s_cbranch_scc1 K2_LEND
    v_rcp_f32 v49, v225
    s_bitcmp1_b32 s32, 18
    s_cselect_b32 s70, -1, 0
    v_rcp_f32 v50, v226
    s_bitcmp1_b32 s32, 22
    v_rcp_f32 v51, v227
    s_cselect_b32 s71, -1, 0
    v_max3_f32 v34, v224, v225, v34
    v_max3_f32 v34, v226, v227, v34
    v_mov_b32_dpp v54, v23 row_newbcast:4 row_mask:0xf bank_mask:0xf
    s_waitcnt lgkmcnt(0)
    v_fmac_f32 v158, v216, v48
    v_fmac_f32 v159, v218, v50
    v_fmac_f32 v158, v217, v49
    v_fmac_f32 v159, v219, v51
    s_mov_b64 exec, s[70:71]
    ds_write2_b32 v33, v158, v159 offset0:64 offset1:96
    v_lshl_add_u32 v33, v54, 1, v15
    ds_read2_b32 v[158:159], v33 offset0:64 offset1:96
    s_mov_b64 exec, -1
    v_pk_add_f32 v[224:225], v[228:229], 1.0 op_sel_hi:[1,0]
    v_pk_add_f32 v[226:227], v[230:231], 1.0 op_sel_hi:[1,0]
    v_pk_mov_b32 v[216:217], v[106:107], v[106:107] op_sel:[0,1]
    v_pk_mov_b32 v[218:219], v[122:123], v[122:123] op_sel:[0,1]
    s_branch R_B0_5
F_B0_6:
    v_rcp_f32 v48, v224
    s_bitcmp1_b32 s32, 25
    s_cbranch_scc1 K2_LEND
    v_rcp_f32 v49, v225
    s_bitcmp1_b32 s32, 24
    s_cselect_b32 s70, -1, 0
    v_rcp_f32 v50, v226
    s_bitcmp1_b32 s32, 28
    v_rcp_f32 v51, v227
    s_cselect_b32 s71, -1, 0
    v_max3_f32 v34, v224, v225, v34
    v_max3_f32 v34, v226, v227, v34
    v_mov_b32_dpp v54, v23 row_newbcast:8 row_mask:0xf bank_mask:0xf
    s_waitcnt lgkmcnt(0)
    v_fmac_f32 v158, v216, v48
    v_fmac_f32 v159, v218, v50
    v_fmac_f32 v158, v217, v49
    v_fmac_f32 v159, v219, v51
    s_mov_b64 exec, s[70:71]
    ds_write2_b32 v33, v158, v159 offset0:64 offset1:96
    v_lshl_add_u32 v33, v54, 1, v15
    ds_read2_b32 v[158:159], v33 offset0:64 offset1:96
    s_mov_b64 exec, -1
    v_pk_add_f32 v[224:225], v[228:229], 1.0 op_sel_hi:[1,0]
    v_pk_add_f32 v[226:227], v[230:231], 1.0 op_sel_hi:[1,0]
    v_pk_mov_b32 v[216:217], v[108:109], v[108:109] op_sel:[0,1]
    v_pk_mov_b32 v[218:219], v[124:125], v[124:125] op_sel:[0,1]
    s_branch R_B0_6
F_B0_7:
    v_rcp_f32 v48, v224
    s_bitcmp1_b32 s32, 27
    s_cbranch_scc1 K2_LEND
    v_rcp_f32 v49, v225
    s_bitcmp1_b32 s32, 26
    s_cselect_b32 s70, -1, 0
    v_rcp_f32 v50, v226
    s_bitcmp1_b32 s32, 30
    v_rcp_f32 v51, v227
    s_cselect_b32 s71, -1, 0
    v_max3_f32 v34, v224, v225, v34
    v_max3_f32 v34, v226, v227, v34
    v_mov_b32_dpp v54, v23 row_newbcast:12 row_mask:0xf bank_mask:0xf
    s_waitcnt lgkmcnt(0)
    v_fmac_f32 v158, v216, v48
    v_fmac_f32 v159, v218, v50
    v_fmac_f32 v158, v217, v49
    v_fmac_f32 v159, v219, v51
    s_mov_b64 exec, s[70:71]
    ds_write2_b32 v33, v158, v159 offset0:64 offset1:96
    v_lshl_add_u32 v33, v54, 1, v15
    ds_read2_b32 v[158:159], v33 offset0:64 offset1:96
    s_mov_b64 exec, -1
    v_pk_add_f32 v[224:225], v[228:229], 1.0 op_sel_hi:[1,0]
    v_pk_add_f32 v[226:227], v[230:231], 1.0 op_sel_hi:[1,0]
    v_pk_mov_b32 v[216:217], v[110:111], v[110:111] op_sel:[0,1]
    v_pk_mov_b32 v[218:219], v[126:127], v[126:127] op_sel:[0,1]
    s_branch R_B0_7
F_A1_0:
    v_rcp_f32 v40, v220
    s_bitcmp1_b32 s34, 0
    v_rcp_f32 v41, v221
    s_cselect_b32 s70, -1, 0
    v_rcp_f32 v42, v222
    s_bitcmp1_b32 s34, 4
    v_rcp_f32 v43, v223
    s_cselect_b32 s71, -1, 0
    v_max3_f32 v34, v220, v221, v34
    v_max3_f32 v34, v222, v223, v34
    v_mov_b32_dpp v46, v24 row_newbcast:0 row_mask:0xf bank_mask:0xf
    s_waitcnt lgkmcnt(0)
    v_fmac_f32 v156, v212, v40
    v_fmac_f32 v157, v214, v42
    v_fmac_f32 v156, v213, v41
    v_fmac_f32 v157, v215, v43
    s_mov_b64 exec, s[70:71]
    ds_write2_b32 v32, v156, v157 offset0:0 offset1:32
    v_lshl_add_u32 v32, v46, 1, v15
    ds_read2_b32 v[156:157], v32 offset0:0 offset1:32
    s_mov_b64 exec, -1
    v_pk_add_f32 v[220:221], v[228:229], 1.0 op_sel_hi:[1,0]
    v_pk_add_f32 v[222:223], v[230:231], 1.0 op_sel_hi:[1,0]
    v_pk_mov_b32 v[212:213], v[64:65], v[64:65] op_sel:[0,1]
    v_pk_mov_b32 v[214:215], v[80:81], v[80:81] op_sel:[0,1]
    s_branch R_A1_0
F_A1_1:
    v_rcp_f32 v40, v220
    s_bitcmp1_b32 s34, 3
    s_cbranch_scc1 EXA1_1
    v_rcp_f32 v41, v221
    s_bitcmp1_b32 s34, 2
    s_cselect_b32 s70, -1, 0
    v_rcp_f32 v42, v222
    s_bitcmp1_b32 s34, 6
    v_rcp_f32 v43, v223
    s_cselect_b32 s71, -1, 0
    v_max3_f32 v34, v220, v221, v34
    v_max3_f32 v34, v222, v223, v34
    v_mov_b32_dpp v46, v24 row_newbcast:4 row_mask:0xf bank_mask:0xf
    s_waitcnt lgkmcnt(0)
    v_fmac_f32 v156, v212, v40
    v_fmac_f32 v157, v214, v42
    v_fmac_f32 v156, v213, v41
    v_fmac_f32 v157, v215, v43
    s_mov_b64 exec, s[70:71]
    ds_write2_b32 v32, v156, v157 offset0:0 offset1:32
    v_lshl_add_u32 v32, v46, 1, v15
    ds_read2_b32 v[156:157], v32 offset0:0 offset1:32
    s_mov_b64 exec, -1
    v_pk_add_f32 v[220:221], v[228:229], 1.0 op_sel_hi:[1,0]
    v_pk_add_f32 v[222:223], v[230:231], 1.0 op_sel_hi:[1,0]
    v_pk_mov_b32 v[212:213], v[66:67], v[66:67] op_sel:[0,1]
    v_pk_mov_b32 v[214:215], v[82:83], v[82:83] op_sel:[0,1]
    s_branch R_A1_1
F_A1_2:
    v_rcp_f32 v40, v220
    s_bitcmp1_b32 s34, 9
    s_cbranch_scc1 EXA1_2
    v_rcp_f32 v41, v221
    s_bitcmp1_b32 s34, 8
    s_cselect_b32 s70, -1, 0
    v_rcp_f32 v42, v222
    s_bitcmp1_b32 s34, 12
    v_rcp_f32 v43, v223
    s_cselect_b32 s71, -1, 0
    v_max3_f32 v34, v220, v221, v34
    v_max3_f32 v34, v222, v223, v34
    v_mov_b32_dpp v46, v24 row_newbcast:8 row_mask:0xf bank_mask:0xf
    s_waitcnt lgkmcnt(0)
    v_fmac_f32 v156, v212, v40
    v_fmac_f32 v157, v214, v42
    v_fmac_f32 v156, v213, v41
    v_fmac_f32 v157, v215, v43
    s_mov_b64 exec, s[70:71]
    ds_write2_b32 v32, v156, v157 offset0:0 offset1:32
    v_lshl_add_u32 v32, v46, 1, v15
    ds_read2_b32 v[156:157], v32 offset0:0 offset1:32
    s_mov_b64 exec, -1
    v_pk_add_f32 v[220:221], v[228:229], 1.0 op_sel_hi:[1,0]
    v_pk_add_f32 v[222:223], v[230:231], 1.0 op_sel_hi:[1,0]
    v_pk_mov_b32 v[212:213], v[68:69], v[68:69] op_sel:[0,1]
    v_pk_mov_b32 v[214:215], v[84:85], v[84:85] op_sel:[0,1]
    s_branch R_A1_2
F_A1_3:
    v_rcp_f32 v40, v220
    s_bitcmp1_b32 s34, 11
    s_cbranch_scc1 EXA1_3
    v_rcp_f32 v41, v221
    s_bitcmp1_b32 s34, 10
    s_cselect_b32 s70, -1, 0
    v_rcp_f32 v42, v222
    s_bitcmp1_b32 s34, 14
    v_rcp_f32 v43, v223
    s_cselect_b32 s71, -1, 0
    v_max3_f32 v34, v220, v221, v34
    v_max3_f32 v34, v222, v223, v34
    v_mov_b32_dpp v46, v24 row_newbcast:12 row_mask:0xf bank_mask:0xf
    s_waitcnt lgkmcnt(0)
    v_fmac_f32 v156, v212, v40
    v_fmac_f32 v157, v214, v42
    v_fmac_f32 v156, v213, v41
    v_fmac_f32 v157, v215, v43
    s_mov_b64 exec, s[70:71]
    ds_write2_b32 v32, v156, v157 offset0:0 offset1:32
    v_lshl_add_u32 v32, v46, 1, v15
    ds_read2_b32 v[156:157], v32 offset0:0 offset1:32
    s_mov_b64 exec, -1
    v_pk_add_f32 v[220:221], v[228:229], 1.0 op_sel_hi:[1,0]
    v_pk_add_f32 v[222:223], v[230:231], 1.0 op_sel_hi:[1,0]
    v_pk_mov_b32 v[212:213], v[70:71], v[70:71] op_sel:[0,1]
    v_pk_mov_b32 v[214:215], v[86:87], v[86:87] op_sel:[0,1]
    s_branch R_A1_3
F_A1_4:
    v_rcp_f32 v40, v220
    s_bitcmp1_b32 s34, 17
    s_cbranch_scc1 EXA1_4
    v_rcp_f32 v41, v221
    s_bitcmp1_b32 s34, 16
    s_cselect_b32 s70, -1, 0
    v_rcp_f32 v42, v222
    s_bitcmp1_b32 s34, 20
    v_rcp_f32 v43, v223
    s_cselect_b32 s71, -1, 0
    v_max3_f32 v34, v220, v221, v34
    v_max3_f32 v34, v222, v223, v34
    v_mov_b32_dpp v46, v25 row_newbcast:0 row_mask:0xf bank_mask:0xf
    s_waitcnt lgkmcnt(0)
    v_fmac_f32 v156, v212, v40
    v_fmac_f32 v157, v214, v42
    v_fmac_f32 v156, v213, v41
    v_fmac_f32 v157, v215, v43
    s_mov_b64 exec, s[70:71]
    ds_write2_b32 v32, v156, v157 offset0:0 offset1:32
    v_lshl_add_u32 v32, v46, 1, v15
    ds_read2_b32 v[156:157], v32 offset0:0 offset1:32
    s_mov_b64 exec, -1
    v_pk_add_f32 v[220:221], v[228:229], 1.0 op_sel_hi:[1,0]
    v_pk_add_f32 v[222:223], v[230:231], 1.0 op_sel_hi:[1,0]
    v_pk_mov_b32 v[212:213], v[72:73], v[72:73] op_sel:[0,1]
    v_pk_mov_b32 v[214:215], v[88:89], v[88:89] op_sel:[0,1]
    s_branch R_A1_4
F_A1_5:
    v_rcp_f32 v40, v220
    s_bitcmp1_b32 s34, 19
    s_cbranch_scc1 EXA1_5
    v_rcp_f32 v41, v221
    s_bitcmp1_b32 s34, 18
    s_cselect_b32 s70, -1, 0
    v_rcp_f32 v42, v222
    s_bitcmp1_b32 s34, 22
    v_rcp_f32 v43, v223
    s_cselect_b32 s71, -1, 0
    v_max3_f32 v34, v220, v221, v34
    v_max3_f32 v34, v222, v223, v34
    v_mov_b32_dpp v46, v25 row_newbcast:4 row_mask:0xf bank_mask:0xf
    s_waitcnt lgkmcnt(0)
    v_fmac_f32 v156, v212, v40
    v_fmac_f32 v157, v214, v42
    v_fmac_f32 v156, v213, v41
    v_fmac_f32 v157, v215, v43
    s_mov_b64 exec, s[70:71]
    ds_write2_b32 v32, v156, v157 offset0:0 offset1:32
    v_lshl_add_u32 v32, v46, 1, v15
    ds_read2_b32 v[156:157], v32 offset0:0 offset1:32
    s_mov_b64 exec, -1
    v_pk_add_f32 v[220:221], v[228:229], 1.0 op_sel_hi:[1,0]
    v_pk_add_f32 v[222:223], v[230:231], 1.0 op_sel_hi:[1,0]
    v_pk_mov_b32 v[212:213], v[74:75], v[74:75] op_sel:[0,1]
    v_pk_mov_b32 v[214:215], v[90:91], v[90:91] op_sel:[0,1]
    s_branch R_A1_5
F_A1_6:
    v_rcp_f32 v40, v220
    s_bitcmp1_b32 s34, 25
    s_cbranch_scc1 R_A1_7
    v_rcp_f32 v41, v221
    s_bitcmp1_b32 s34, 24
    s_cselect_b32 s70, -1, 0
    v_rcp_f32 v42, v222
    s_bitcmp1_b32 s34, 28
    v_rcp_f32 v43, v223
    s_cselect_b32 s71, -1, 0
    v_max3_f32 v34, v220, v221, v34
    v_max3_f32 v34, v222, v223, v34
    v_mov_b32_dpp v46, v25 row_newbcast:8 row_mask:0xf bank_mask:0xf
    s_waitcnt lgkmcnt(0)
    v_fmac_f32 v156, v212, v40
    v_fmac_f32 v157, v214, v42
    v_fmac_f32 v156, v213, v41
    v_fmac_f32 v157, v215, v43
    s_mov_b64 exec, s[70:71]
    ds_write2_b32 v32, v156, v157 offset0:0 offset1:32
    v_lshl_add_u32 v32, v46, 1, v15
    ds_read2_b32 v[156:157], v32 offset0:0 offset1:32
    s_mov_b64 exec, -1
    v_pk_add_f32 v[220:221], v[228:229], 1.0 op_sel_hi:[1,0]
    v_pk_add_f32 v[222:223], v[230:231], 1.0 op_sel_hi:[1,0]
    v_pk_mov_b32 v[212:213], v[76:77], v[76:77] op_sel:[0,1]
    v_pk_mov_b32 v[214:215], v[92:93], v[92:93] op_sel:[0,1]
    s_branch R_A1_6
F_A1_7:
    v_rcp_f32 v40, v220
    s_bitcmp1_b32 s34, 27
    s_cbranch_scc1 R_A1_7
    v_rcp_f32 v41, v221
    s_bitcmp1_b32 s34, 26
    s_cselect_b32 s70, -1, 0
    v_rcp_f32 v42, v222
    s_bitcmp1_b32 s34, 30
    v_rcp_f32 v43, v223
    s_cselect_b32 s71, -1, 0
    v_max3_f32 v34, v220, v221, v34
    v_max3_f32 v34, v222, v223, v34
    v_mov_b32_dpp v46, v25 row_newbcast:12 row_mask:0xf bank_mask:0xf
    s_waitcnt lgkmcnt(0)
    v_fmac_f32 v156, v212, v40
    v_fmac_f32 v157, v214, v42
    v_fmac_f32 v156, v213, v41
    v_fmac_f32 v157, v215, v43
    s_mov_b64 exec, s[70:71]
    ds_write2_b32 v32, v156, v157 offset0:0 offset1:32
    v_lshl_add_u32 v32, v46, 1, v15
    ds_read2_b32 v[156:157], v32 offset0:0 offset1:32
    s_mov_b64 exec, -1
    v_pk_add_f32 v[220:221], v[228:229], 1.0 op_sel_hi:[1,0]
    v_pk_add_f32 v[222:223], v[230:231], 1.0 op_sel_hi:[1,0]
    v_pk_mov_b32 v[212:213], v[78:79], v[78:79] op_sel:[0,1]
    v_pk_mov_b32 v[214:215], v[94:95], v[94:95] op_sel:[0,1]
    s_branch R_A1_7
WU2_1:
    s_mov_b32 s26, 0
    s_mov_b32 s30, 0
    s_or_b64 s[32:33], s[32:33], s[52:53]
    s_cmp_lg_u32 s57, 0
    s_cbranch_scc1 WU2R_1
    s_add_u32 s70, s64, 32768
    s_add_u32 m0, s64, 65536
    s_nop 0
    buffer_load_dwordx4 v35, s[48:51], s70 offen lds
    buffer_load_dwordx4 v35, s[48:51], s70 offen offset:1024 lds
    buffer_load_dwordx4 v35, s[48:51], s70 offen offset:2048 lds
    buffer_load_dwordx4 v35, s[48:51], s70 offen offset:3072 lds
    s_branch WU2R_1
    s_nop 0
EXA1_1:
    s_waitcnt lgkmcnt(0)
    v_mfma_f32_32x32x16_bf16 v[96:111], v[184:187], v[160:163], v[96:111]
EXA1_2:
    v_mfma_f32_32x32x16_bf16 v[112:127], v[184:187], v[164:167], v[112:127]
EXA1_3:
    v_smfmac_f32_32x32x32_bf16 v[96:111], v[188:191], v[128:135], v192
    s_add_u32 s70, s64, 32768
    s_add_u32 m0, s64, 65536
    s_nop 0
    buffer_load_dwordx4 v35, s[48:51], s70 offen lds
    buffer_load_dwordx4 v35, s[48:51], s70 offen offset:1024 lds
    buffer_load_dwordx4 v35, s[48:51], s70 offen offset:2048 lds
    buffer_load_dwordx4 v35, s[48:51], s70 offen offset:3072 lds
EXA1_4:
    v_smfmac_f32_32x32x32_bf16 v[112:127], v[188:191], v[136:143], v192
    s_nop 7
EXA1_5:
    s_branch R_A1_7
F_B1_0:
    v_rcp_f32 v48, v224
    s_bitcmp1_b32 s34, 0
    v_rcp_f32 v49, v225
    s_cselect_b32 s70, -1, 0
    v_rcp_f32 v50, v226
    s_bitcmp1_b32 s34, 4
    v_rcp_f32 v51, v227
    s_cselect_b32 s71, -1, 0
    v_max3_f32 v34, v224, v225, v34
    v_max3_f32 v34, v226, v227, v34
    v_mov_b32_dpp v54, v24 row_newbcast:0 row_mask:0xf bank_mask:0xf
    s_waitcnt lgkmcnt(0)
    v_fmac_f32 v158, v216, v48
    v_fmac_f32 v159, v218, v50
    v_fmac_f32 v158, v217, v49
    v_fmac_f32 v159, v219, v51
    s_mov_b64 exec, s[70:71]
    ds_write2_b32 v33, v158, v159 offset0:64 offset1:96
    v_lshl_add_u32 v33, v54, 1, v15
    ds_read2_b32 v[158:159], v33 offset0:64 offset1:96
    s_mov_b64 exec, -1
    v_pk_add_f32 v[224:225], v[228:229], 1.0 op_sel_hi:[1,0]
    v_pk_add_f32 v[226:227], v[230:231], 1.0 op_sel_hi:[1,0]
    v_pk_mov_b32 v[216:217], v[96:97], v[96:97] op_sel:[0,1]
    v_pk_mov_b32 v[218:219], v[112:113], v[112:113] op_sel:[0,1]
    s_branch R_B1_0
F_B1_1:
    v_rcp_f32 v48, v224
    s_bitcmp1_b32 s34, 3
    s_cbranch_scc1 K2_LEND
    v_rcp_f32 v49, v225
    s_bitcmp1_b32 s34, 2
    s_cselect_b32 s70, -1, 0
    v_rcp_f32 v50, v226
    s_bitcmp1_b32 s34, 6
    v_rcp_f32 v51, v227
    s_cselect_b32 s71, -1, 0
    v_max3_f32 v34, v224, v225, v34
    v_max3_f32 v34, v226, v227, v34
    v_mov_b32_dpp v54, v24 row_newbcast:4 row_mask:0xf bank_mask:0xf
    s_waitcnt lgkmcnt(0)
    v_fmac_f32 v158, v216, v48
    v_fmac_f32 v159, v218, v50
    v_fmac_f32 v158, v217, v49
    v_fmac_f32 v159, v219, v51
    s_mov_b64 exec, s[70:71]
    ds_write2_b32 v33, v158, v159 offset0:64 offset1:96
    v_lshl_add_u32 v33, v54, 1, v15
    ds_read2_b32 v[158:159], v33 offset0:64 offset1:96
    s_mov_b64 exec, -1
    v_pk_add_f32 v[224:225], v[228:229], 1.0 op_sel_hi:[1,0]
    v_pk_add_f32 v[226:227], v[230:231], 1.0 op_sel_hi:[1,0]
    v_pk_mov_b32 v[216:217], v[98:99], v[98:99] op_sel:[0,1]
    v_pk_mov_b32 v[218:219], v[114:115], v[114:115] op_sel:[0,1]
    s_branch R_B1_1
F_B1_2:
    v_rcp_f32 v48, v224
    s_bitcmp1_b32 s34, 9
    s_cbranch_scc1 K2_LEND
    v_rcp_f32 v49, v225
    s_bitcmp1_b32 s34, 8
    s_cselect_b32 s70, -1, 0
    v_rcp_f32 v50, v226
    s_bitcmp1_b32 s34, 12
    v_rcp_f32 v51, v227
    s_cselect_b32 s71, -1, 0
    v_max3_f32 v34, v224, v225, v34
    v_max3_f32 v34, v226, v227, v34
    v_mov_b32_dpp v54, v24 row_newbcast:8 row_mask:0xf bank_mask:0xf
    s_waitcnt lgkmcnt(0)
    v_fmac_f32 v158, v216, v48
    v_fmac_f32 v159, v218, v50
    v_fmac_f32 v158, v217, v49
    v_fmac_f32 v159, v219, v51
    s_mov_b64 exec, s[70:71]
    ds_write2_b32 v33, v158, v159 offset0:64 offset1:96
    v_lshl_add_u32 v33, v54, 1, v15
    ds_read2_b32 v[158:159], v33 offset0:64 offset1:96
    s_mov_b64 exec, -1
    v_pk_add_f32 v[224:225], v[228:229], 1.0 op_sel_hi:[1,0]
    v_pk_add_f32 v[226:227], v[230:231], 1.0 op_sel_hi:[1,0]
    v_pk_mov_b32 v[216:217], v[100:101], v[100:101] op_sel:[0,1]
    v_pk_mov_b32 v[218:219], v[116:117], v[116:117] op_sel:[0,1]
    s_branch R_B1_2
F_B1_3:
    v_rcp_f32 v48, v224
    s_bitcmp1_b32 s34, 11
    s_cbranch_scc1 K2_LEND
    v_rcp_f32 v49, v225
    s_bitcmp1_b32 s34, 10
    s_cselect_b32 s70, -1, 0
    v_rcp_f32 v50, v226
    s_bitcmp1_b32 s34, 14
    v_rcp_f32 v51, v227
    s_cselect_b32 s71, -1, 0
    v_max3_f32 v34, v224, v225, v34
    v_max3_f32 v34, v226, v227, v34
    v_mov_b32_dpp v54, v24 row_newbcast:12 row_mask:0xf bank_mask:0xf
    s_waitcnt lgkmcnt(0)
    v_fmac_f32 v158, v216, v48
    v_fmac_f32 v159, v218, v50
    v_fmac_f32 v158, v217, v49
    v_fmac_f32 v159, v219, v51
    s_mov_b64 exec, s[70:71]
    ds_write2_b32 v33, v158, v159 offset0:64 offset1:96
    v_lshl_add_u32 v33, v54, 1, v15
    ds_read2_b32 v[158:159], v33 offset0:64 offset1:96
    s_mov_b64 exec, -1
    v_pk_add_f32 v[224:225], v[228:229], 1.0 op_sel_hi:[1,0]
    v_pk_add_f32 v[226:227], v[230:231], 1.0 op_sel_hi:[1,0]
    v_pk_mov_b32 v[216:217], v[102:103], v[102:103] op_sel:[0,1]
    v_pk_mov_b32 v[218:219], v[118:119], v[118:119] op_sel:[0,1]
    s_branch R_B1_3
F_B1_4:
    v_rcp_f32 v48, v224
    s_bitcmp1_b32 s34, 17
    s_cbranch_scc1 K2_LEND
    v_rcp_f32 v49, v225
    s_bitcmp1_b32 s34, 16
    s_cselect_b32 s70, -1, 0
    v_rcp_f32 v50, v226
    s_bitcmp1_b32 s34, 20
    v_rcp_f32 v51, v227
    s_cselect_b32 s71, -1, 0
    v_max3_f32 v34, v224, v225, v34
    v_max3_f32 v34, v226, v227, v34
    v_mov_b32_dpp v54, v25 row_newbcast:0 row_mask:0xf bank_mask:0xf
    s_waitcnt lgkmcnt(0)
    v_fmac_f32 v158, v216, v48
    v_fmac_f32 v159, v218, v50
    v_fmac_f32 v158, v217, v49
    v_fmac_f32 v159, v219, v51
    s_mov_b64 exec, s[70:71]
    ds_write2_b32 v33, v158, v159 offset0:64 offset1:96
    v_lshl_add_u32 v33, v54, 1, v15
    ds_read2_b32 v[158:159], v33 offset0:64 offset1:96
    s_mov_b64 exec, -1
    v_pk_add_f32 v[224:225], v[228:229], 1.0 op_sel_hi:[1,0]
    v_pk_add_f32 v[226:227], v[230:231], 1.0 op_sel_hi:[1,0]
    v_pk_mov_b32 v[216:217], v[104:105], v[104:105] op_sel:[0,1]
    v_pk_mov_b32 v[218:219], v[120:121], v[120:121] op_sel:[0,1]
    s_branch R_B1_4
F_B1_5:
    v_rcp_f32 v48, v224
    s_bitcmp1_b32 s34, 19
    s_cbranch_scc1 K2_LEND
    v_rcp_f32 v49, v225
    s_bitcmp1_b32 s34, 18
    s_cselect_b32 s70, -1, 0
    v_rcp_f32 v50, v226
    s_bitcmp1_b32 s34, 22
    v_rcp_f32 v51, v227
    s_cselect_b32 s71, -1, 0
    v_max3_f32 v34, v224, v225, v34
    v_max3_f32 v34, v226, v227, v34
    v_mov_b32_dpp v54, v25 row_newbcast:4 row_mask:0xf bank_mask:0xf
    s_waitcnt lgkmcnt(0)
    v_fmac_f32 v158, v216, v48
    v_fmac_f32 v159, v218, v50
    v_fmac_f32 v158, v217, v49
    v_fmac_f32 v159, v219, v51
    s_mov_b64 exec, s[70:71]
    ds_write2_b32 v33, v158, v159 offset0:64 offset1:96
    v_lshl_add_u32 v33, v54, 1, v15
    ds_read2_b32 v[158:159], v33 offset0:64 offset1:96
    s_mov_b64 exec, -1
    v_pk_add_f32 v[224:225], v[228:229], 1.0 op_sel_hi:[1,0]
    v_pk_add_f32 v[226:227], v[230:231], 1.0 op_sel_hi:[1,0]
    v_pk_mov_b32 v[216:217], v[106:107], v[106:107] op_sel:[0,1]
    v_pk_mov_b32 v[218:219], v[122:123], v[122:123] op_sel:[0,1]
    s_branch R_B1_5
F_B1_6:
    v_rcp_f32 v48, v224
    s_bitcmp1_b32 s34, 25
    s_cbranch_scc1 K2_LEND
    v_rcp_f32 v49, v225
    s_bitcmp1_b32 s34, 24
    s_cselect_b32 s70, -1, 0
    v_rcp_f32 v50, v226
    s_bitcmp1_b32 s34, 28
    v_rcp_f32 v51, v227
    s_cselect_b32 s71, -1, 0
    v_max3_f32 v34, v224, v225, v34
    v_max3_f32 v34, v226, v227, v34
    v_mov_b32_dpp v54, v25 row_newbcast:8 row_mask:0xf bank_mask:0xf
    s_waitcnt lgkmcnt(0)
    v_fmac_f32 v158, v216, v48
    v_fmac_f32 v159, v218, v50
    v_fmac_f32 v158, v217, v49
    v_fmac_f32 v159, v219, v51
    s_mov_b64 exec, s[70:71]
    ds_write2_b32 v33, v158, v159 offset0:64 offset1:96
    v_lshl_add_u32 v33, v54, 1, v15
    ds_read2_b32 v[158:159], v33 offset0:64 offset1:96
    s_mov_b64 exec, -1
    v_pk_add_f32 v[224:225], v[228:229], 1.0 op_sel_hi:[1,0]
    v_pk_add_f32 v[226:227], v[230:231], 1.0 op_sel_hi:[1,0]
    v_pk_mov_b32 v[216:217], v[108:109], v[108:109] op_sel:[0,1]
    v_pk_mov_b32 v[218:219], v[124:125], v[124:125] op_sel:[0,1]
    s_branch R_B1_6
F_B1_7:
    v_rcp_f32 v48, v224
    s_bitcmp1_b32 s34, 27
    s_cbranch_scc1 K2_LEND
    v_rcp_f32 v49, v225
    s_bitcmp1_b32 s34, 26
    s_cselect_b32 s70, -1, 0
    v_rcp_f32 v50, v226
    s_bitcmp1_b32 s34, 30
    v_rcp_f32 v51, v227
    s_cselect_b32 s71, -1, 0
    v_max3_f32 v34, v224, v225, v34
    v_max3_f32 v34, v226, v227, v34
    v_mov_b32_dpp v54, v25 row_newbcast:12 row_mask:0xf bank_mask:0xf
    s_waitcnt lgkmcnt(0)
    v_fmac_f32 v158, v216, v48
    v_fmac_f32 v159, v218, v50
    v_fmac_f32 v158, v217, v49
    v_fmac_f32 v159, v219, v51
    s_mov_b64 exec, s[70:71]
    ds_write2_b32 v33, v158, v159 offset0:64 offset1:96
    v_lshl_add_u32 v33, v54, 1, v15
    ds_read2_b32 v[158:159], v33 offset0:64 offset1:96
    s_mov_b64 exec, -1
    v_pk_add_f32 v[224:225], v[228:229], 1.0 op_sel_hi:[1,0]
    v_pk_add_f32 v[226:227], v[230:231], 1.0 op_sel_hi:[1,0]
    v_pk_mov_b32 v[216:217], v[110:111], v[110:111] op_sel:[0,1]
    v_pk_mov_b32 v[218:219], v[126:127], v[126:127] op_sel:[0,1]
    s_branch R_B1_7
K2_CODE_END:
K2_PRO2:
    s_waitcnt vmcnt(0)
    ds_read_b32 v30, v7 offset:0
    ds_read2_b32 v[148:149], v8 offset0:0 offset1:8
    ds_read2_b32 v[150:151], v8 offset0:16 offset1:24
    ds_read_u16 v28, v9 offset:0
    ds_read_u16 v29, v9 offset:64
    s_waitcnt lgkmcnt(0)
    v_mad_u32_u16 v144, v148, s79, v152
    v_mad_u32_u16 v145, v149, s79, v153
    v_mad_u32_u16 v146, v150, s79, v154
    v_mad_u32_u16 v147, v151, s79, v155
    v_and_or_b32 v20, v30, s66, v16
    v_and_or_b32 v21, v30, 16, v14
    v_cmp_gt_i32 vcc, 0, v30
    v_add_u32 v22, v28, v13
    v_add_u32 v23, v29, v13
    ds_read_b32 v30, v7 offset:128
    ds_read2_b32 v[148:149], v8 offset0:32 offset1:40
    ds_read2_b32 v[150:151], v8 offset0:48 offset1:56
    s_lshr_b32 s33, vcc_lo, 4
    s_mov_b32 s32, vcc_lo
    s_or_b32 s33, s33, vcc_lo
    s_or_b32 s33, s33, s63
    s_add_u32 m0, s64, 65536
    s_nop 0
    buffer_load_dwordx4 v144, s[24:27], 0 offen  lds
    buffer_load_dwordx4 v145, s[24:27], 0 offen offset:1024  lds
    buffer_load_dwordx4 v[176:179], v20, s[28:31], 0 offen
    v_cmp_ne_u32 vcc, v21, v14
    v_mov_b32_dpp v17, v22 row_newbcast:0 row_mask:0xf bank_mask:0xf
    v_mov_b32 v60, v21
    buffer_load_dwordx4 v146, s[24:27], 0 offen offset:2048  lds
    s_cmp_eq_u32 s56, 0
    s_cselect_b32 s69, -1, vcc_lo
    v_lshl_add_u32 v17, v17, 1, v15
    buffer_load_dwordx4 v147, s[24:27], 0 offen offset:3072  lds
    s_add_u32 m0, s65, 4224
    s_nop 0
    buffer_load_dwordx4 v144, s[24:27], 0 offen offset:128  lds
    buffer_load_dwordx4 v145, s[24:27], 0 offen offset:1152  lds
    buffer_load_dwordx4 v146, s[24:27], 0 offen offset:2176  lds
    buffer_load_dwordx4 v147, s[24:27], 0 offen offset:3200  lds
    s_cmp_lt_u32 s56, 2
    s_cselect_b32 s26, 0, s26
    s_cselect_b32 s30, 0, s30
    s_waitcnt lgkmcnt(0)
    v_mad_u32_u16 v144, v148, s79, v152
    v_mad_u32_u16 v145, v149, s79, v153
    v_mad_u32_u16 v146, v150, s79, v154
    v_mad_u32_u16 v147, v151, s79, v155
    v_and_or_b32 v20, v30, s66, v16
    v_and_or_b32 v21, v30, 16, v14
    v_cmp_gt_i32 vcc, 0, v30
    ds_read_b32 v30, v7 offset:256
    ds_read2_b32 v[148:149], v8 offset0:64 offset1:72
    ds_read2_b32 v[150:151], v8 offset0:80 offset1:88
    ds_read_u16 v28, v9 offset:128
    ds_read_u16 v29, v9 offset:192
    s_lshr_b32 s35, vcc_lo, 4
    s_mov_b32 s34, vcc_lo
    s_or_b32 s35, s35, vcc_lo
    s_or_b32 s35, s35, s63
    s_branch K2_NOX
K2_NOTILES:
    s_waitcnt vmcnt(0)
    s_add_u32 s70, s64, 32768
    s_add_u32 m0, s64, 65536
    s_nop 0
    buffer_load_dwordx4 v35, s[48:51], s70 offen lds
    buffer_load_dwordx4 v35, s[48:51], s70 offen offset:1024 lds
    buffer_load_dwordx4 v35, s[48:51], s70 offen offset:2048 lds
    buffer_load_dwordx4 v35, s[48:51], s70 offen offset:3072 lds
    s_branch K2_AFTER
K2_SLOWM:
    ds_read_b32 v56, v31 offset:0
    ds_read_b32 v57, v31 offset:128
    ds_read_b32 v58, v31 offset:256
    ds_read_b32 v59, v31 offset:384
    s_waitcnt vmcnt(0) lgkmcnt(0)
    s_barrier
    s_mov_b64 exec, s[82:83]
    ds_add_f32 v17, v56 offset:0
    ds_add_f32 v17, v57 offset:128
    ds_add_f32 v17, v58 offset:256
    ds_add_f32 v17, v59 offset:384
    s_branch K2_MERGED
K2_SAFE:
    s_waitcnt vmcnt(0)
    s_barrier
    s_mov_b32 s63, -1
    s_mov_b32 s62, 0
    v_lshlrev_b32 v40, 4, v0
    v_mov_b32 v48, 0
    v_mov_b32 v49, 0
    v_mov_b32 v50, 0
    v_mov_b32 v51, 0
    s_movk_i32 s70, 17
    v_cmp_gt_u32 vcc, s70, v0
    s_and_saveexec_b64 s[80:81], vcc
    ds_write_b128 v40, v[48:51] offset:0
    s_mov_b64 exec, s[80:81]
    ds_write_b128 v40, v[48:51] offset:30800
    ds_write_b128 v40, v[48:51] offset:38992
    ds_write_b128 v40, v[48:51] offset:47184
    s_movk_i32 s70, 81
    v_cmp_gt_u32 vcc, s70, v0
    s_and_saveexec_b64 s[80:81], vcc
    ds_write_b128 v40, v[48:51] offset:55376
    s_mov_b64 exec, s[80:81]
    s_branch K2_ROUND
K2_MORE:
    s_mov_b64 exec, -1
    s_add_u32 s62, s62, s61
    s_branch K2_RESET
K2_TOOBIG:
    s_barrier
    s_mov_b32 s61, 16
K2_RESET:
    v_lshlrev_b32 v40, 4, v0
    v_mov_b32 v48, 0
    v_mov_b32 v49, 0
    v_mov_b32 v50, 0
    v_mov_b32 v51, 0
    s_movk_i32 s70, 17
    v_cmp_gt_u32 vcc, s70, v0
    s_and_saveexec_b64 s[80:81], vcc
    ds_write_b128 v40, v[48:51] offset:0
    s_mov_b64 exec, s[80:81]
K2_ROUND:
    s_add_u32 s40, s20, 3276800
    s_addc_u32 s41, s21, 0
    s_mov_b32 s42, 8060928
    s_mov_b32 s43, 0x20000
    v_and_b32 v52, 0x1fc, v0
    s_lshl_b32 s70, s23, 10
    s_add_u32 s70, s70, 7798784
    v_mov_b32 v5, 0
    v_cmp_lt_u32 vcc, 32, v3
    s_mov_b64 exec, vcc
    buffer_load_dword v5, v52, s[40:43], s70 offen
    s_mov_b64 exec, -1
    v_and_b32 v63, 3, v0
    v_lshlrev_b32 v63, 2, v63
    v_add_u32 v63, s62, v63
    s_lshl_b32 s70, s23, 7
    v_lshl_add_u32 v52, v52, 13, s70
    s_mov_b32 s70, 6160380
    s_waitcnt vmcnt(0)
    v_add_u32 v54, v6, v5
    v_lshl_add_u32 v54, v54, 2, s70
    v_add_u32 v55, 0, v63
    v_cmp_gt_u32 vcc, 32, v55
    s_nop 1
    v_cndmask_b32 v56, v54, v52, vcc
    v_lshl_add_u32 v56, v55, 2, v56
    buffer_load_dwordx4 v[160:163], v56, s[40:43], 0 offen
    v_add_u32 v55, 16, v63
    v_cmp_gt_u32 vcc, 32, v55
    s_nop 1
    v_cndmask_b32 v57, v54, v52, vcc
    v_lshl_add_u32 v57, v55, 2, v57
    buffer_load_dwordx4 v[164:167], v57, s[40:43], 0 offen
    v_lshrrev_b32 v52, 3, v2
    v_and_b32 v53, 3, v1
    v_lshl_add_u32 v7, v52, 2, v53
    v_lshlrev_b32 v7, 3, v7
    v_bfe_u32 v53, v1, 2, 2
    v_lshlrev_b32 v9, 4, v53
    v_and_b32 v8, 24, v1
    v_and_b32 v52, 7, v1
    v_bfe_u32 v53, v1, 4, 1
    v_lshlrev_b32 v52, 4, v52
    v_lshlrev_b32 v53, 6, v53
    v_xor_b32 v155, v52, v53
    v_add_u32 v152, 3072, v155
    v_add_u32 v153, 2048, v155
    v_add_u32 v154, 1024, v155
    v_mov_b32 v40, 1
    v_mov_b32 v41, 256
    v_lshlrev_b32 v42, 2, v1
    s_mov_b32 s70, 0x420000
    s_brev_b32 s76, 1
    s_add_u32 s77, s62, s61
    v_cmp_ne_u32 s[82:83], 0, v63
    s_waitcnt vmcnt(0) lgkmcnt(0)
    s_barrier
    s_branch K2_COUNT
.section .rodata,"a"
.p2align 6
.amdhsa_kernel prep_kernel
  .amdhsa_next_free_vgpr 160
  .amdhsa_next_free_sgpr 80
  .amdhsa_accum_offset 160
  .amdhsa_group_segment_fixed_size 0
  .amdhsa_kernarg_size 72
  .amdhsa_user_sgpr_count 2
  .amdhsa_user_sgpr_kernarg_segment_ptr 1
  .amdhsa_system_sgpr_workgroup_id_x 1
.end_amdhsa_kernel
.p2align 6
.amdhsa_kernel gather_scatter__mpnn_edge_mlp__graph_kernel
  .amdhsa_next_free_vgpr 256
  .amdhsa_next_free_sgpr 96
  .amdhsa_accum_offset 256
  .amdhsa_group_segment_fixed_size 0
  .amdhsa_kernarg_size 72
  .amdhsa_user_sgpr_count 2
  .amdhsa_user_sgpr_kernarg_segment_ptr 1
  .amdhsa_system_sgpr_workgroup_id_x 1
.end_amdhsa_kernel
```
